```python
import torch

def _softmax(x, axis=-1):
    return torch.softmax(x, dim=axis)
def _gelu(x):
    return torch.nn.functional.gelu(x, approximate="tanh")
def _silu(x):
    return torch.nn.functional.silu(x)
def _sigmoid(x):
    return torch.sigmoid(x)
def _layernorm(x, axis=-1, eps=1e-5):
    m = x.mean(dim=axis, keepdim=True)
    v = x.var(dim=axis, keepdim=True, unbiased=False)
    return (x - m) / torch.sqrt(v + eps)
def _scatter_add(tgt, idx, src, axis=0):
    return tgt.clone().index_add_(axis, idx, src)
def _segment_sum(src, seg, n):
    out = torch.zeros((n,) + src.shape[1:], dtype=src.dtype)
    return out.index_add_(0, seg, src)
def _pad(x, pw):
    flat = tuple(v for pair in reversed(pw) for v in pair)
    return torch.nn.functional.pad(x, flat)

kernel_name = 'parallel_sum__gqa_block_cached__glu_gated_reglu__decode'

def setup_inputs():

    _w = (lambda a: (lambda t: t.to(torch.bfloat16) if t.is_floating_point() else t)(torch.as_tensor(a)))
    def _A_setup():
        B, Sq, D = 1, 1, 640
        Hq, Hkv, Sk, Dh = 32, 32, 16384, 192
        assert Hq % Hkv == 0, (Hq, Hkv)
        return {
            "x": _w((lambda *s: torch.randn(*s, dtype=torch.bfloat16) * 0.05)(B, Sq, D)),
            "k_cache": _w((lambda *s: torch.randn(*s, dtype=torch.bfloat16) * 3.2)(B, Hkv, Sk, Dh)),
            "v_cache": _w((lambda *s: torch.randn(*s, dtype=torch.bfloat16) * 1.6)(B, Hkv, Sk, Dh)),
            "wq": _w((lambda *s: torch.randn(*s, dtype=torch.bfloat16) * 3.2)(D, Hq * Dh) * (D ** -0.5)),
            "wo": _w((lambda *s: torch.randn(*s, dtype=torch.bfloat16) * 1.6)(Hq * Dh, D) * ((Hq * Dh) ** -0.5)),
        }
    _A_in = _A_setup()

    def _B_setup():
        B, S, D, F = 1, 1, 640, 1536
        return {
            "x": _w((lambda *s: torch.randn(*s, dtype=torch.bfloat16) * 0.05)(B, S, D)),
            "W_gate": _w((lambda *s: torch.randn(*s, dtype=torch.bfloat16) * 1.6)(D, F) * (2.0 / D) ** 0.5),
            "W_up": _w((lambda *s: torch.randn(*s, dtype=torch.bfloat16) * 1.6)(D, F) * (2.0 / D) ** 0.5),
            "W_down": _w((lambda *s: torch.randn(*s, dtype=torch.bfloat16) * 1.6)(F, D) * (1.0 / F) ** 0.5),
        }
    _B_in = _B_setup()

    return {
        "A_x": _A_in["x"],
        "A_k_cache": _A_in["k_cache"],
        "A_v_cache": _A_in["v_cache"],
        "A_wq": _A_in["wq"],
        "A_wo": _A_in["wo"],
        "B_x": _B_in["x"],
        "B_W_gate": _B_in["W_gate"],
        "B_W_up": _B_in["W_up"],
        "B_W_down": _B_in["W_down"],
    }

def reference(A_x, A_k_cache, A_v_cache, A_wq, A_wo, B_x, B_W_gate, B_W_up, B_W_down):
    def _A_ref(x, k_cache, v_cache, wq, wo):
        B, Sq, D = x.shape
        Hq, Dh = 32, 192
        Hkv = k_cache.shape[1]
        rep = Hq // Hkv
        q = (lambda x, *d: x.permute(*d))((x @ wq).reshape(B, Sq, Hq, Dh), 0, 2, 1, 3)
        k = (lambda x, n, axis: torch.repeat_interleave(x, n, dim=axis))(k_cache, rep, axis=1)
        v = (lambda x, n, axis: torch.repeat_interleave(x, n, dim=axis))(v_cache, rep, axis=1)
        scores = torch.einsum("bhqd,bhkd->bhqk", q, k) * (Dh ** -0.5)
        p = _softmax(scores, axis=-1)
        o = torch.einsum("bhqk,bhkd->bhqd", p, v)
        return (lambda x, *d: x.permute(*d))(o, 0, 2, 1, 3).reshape(B, Sq, Hq * Dh) @ wo

    def _B_ref(x, W_gate, W_up, W_down):
        gate = torch.einsum("bsd,df->bsf", x, W_gate)
        up = torch.einsum("bsd,df->bsf", x, W_up)
        gate = gate * (lambda x, dt: x.to(dt))(gate > 0, gate.dtype)
        h = gate * up
        return torch.einsum("bsf,fd->bsd", h, W_down)

    x = A_x
    xn = _layernorm(x, axis=-1)
    return x + _A_ref(xn, A_k_cache, A_v_cache, A_wq, A_wo) + _B_ref(xn, B_W_gate, B_W_up, B_W_down)
```

```asm
; @launch grid=(256,1,1) block=(320,1,1) lds=15952
.amdgcn_target "amdgcn-amd-amdhsa--gfx950"
.text
.globl parallel_sum__gqa_block_cached__glu_gated_reglu__decode_kernel
.p2align 8
.type parallel_sum__gqa_block_cached__glu_gated_reglu__decode_kernel,@function
parallel_sum__gqa_block_cached__glu_gated_reglu__decode_kernel:
s_cmp_ge_u32 s2, 256
s_cbranch_scc1 L_end
s_load_dwordx16 s[64:79], s[0:1], 0
s_load_dwordx8 s[80:87], s[0:1], 64
s_memrealtime s[28:29]
v_lshrrev_b32 v1, 6, v0
v_and_b32 v0, 63, v0
v_readfirstlane_b32 s3, v1
s_and_b32 s4, s2, 7
s_lshl_b32 s4, s4, 5
s_lshr_b32 s5, s2, 3
s_add_u32 s4, s4, s5
s_lshr_b32 s5, s4, 3
s_and_b32 s6, s4, 7
s_mov_b32 s60, 0xffff0000
s_mov_b32 s61, 0x3d93cd3a
s_mov_b32 s62, 0x3fb8aa3b
v_lshrrev_b32 v36, 3, v0
v_and_b32 v37, 7, v0
v_lshlrev_b32 v38, 4, v37
v_and_b32 v39, 1, v0
v_lshlrev_b32 v39, 4, v39
v_mov_b32 v34, 0xffff
v_lshlrev_b32 v39, v39, v34
v_lshrrev_b32 v35, 1, v37
v_cmp_eq_u32 vcc, 0, v35
s_nop 1
v_cndmask_b32 v4, 0, v39, vcc
v_cmp_eq_u32 vcc, 1, v35
s_nop 1
v_cndmask_b32 v5, 0, v39, vcc
v_cmp_eq_u32 vcc, 2, v35
s_nop 1
v_cndmask_b32 v6, 0, v39, vcc
v_cmp_eq_u32 vcc, 3, v35
s_nop 1
v_cndmask_b32 v7, 0, v39, vcc
s_mov_b32 s36, 0x00ff00ff
s_mov_b32 s37, 0xff00ff00
s_cmp_eq_u32 s3, 4
s_cbranch_scc1 L_helper
v_mul_u32_u24 v1, 384, v36
v_add_u32 v1, v1, v38
s_mul_i32 s7, s5, 6291456
s_lshl_b32 s38, s6, 2
s_add_u32 s38, s38, s3
s_mul_i32 s38, s38, 3072
s_add_u32 s7, s7, s38
s_waitcnt lgkmcnt(0)
s_mov_b32 s8, s66
s_mov_b32 s9, s67
s_mov_b32 s10, 201326592
s_mov_b32 s11, 0x20000
s_add_u32 s39, s7, 0
buffer_load_dwordx4 v[56:59], v1, s[8:11], s39 offen offset:0 nt
buffer_load_dwordx4 v[60:63], v1, s[8:11], s39 offen offset:128 nt
buffer_load_dwordx4 v[64:67], v1, s[8:11], s39 offen offset:256 nt
s_add_u32 s39, s7, 98304
buffer_load_dwordx4 v[68:71], v1, s[8:11], s39 offen offset:0 nt
buffer_load_dwordx4 v[72:75], v1, s[8:11], s39 offen offset:128 nt
buffer_load_dwordx4 v[76:79], v1, s[8:11], s39 offen offset:256 nt
s_mov_b32 s12, s68
s_mov_b32 s13, s69
s_mov_b32 s14, 201326592
s_mov_b32 s15, 0x20000
s_mov_b32 s16, s86
s_mov_b32 s17, s87
s_mov_b32 s18, 805306368
s_mov_b32 s19, 0x20000
s_mov_b32 s20, s72
s_mov_b32 s21, s73
s_mov_b32 s22, 7864320
s_mov_b32 s23, 0x20000
s_mov_b32 s24, s82
s_mov_b32 s25, s83
s_mov_b32 s26, 1280
s_mov_b32 s27, 0x20000
s_load_dword s63, s[86:87], 0
s_min_u32 s38, s2, 39
s_lshl_b32 s90, s38, 5
v_lshrrev_b32 v20, 5, v0
v_mul_u32_u24 v20, 768, v20
v_lshlrev_b32 v21, 5, v37
v_add_u32 v20, v20, v21
v_and_b32 v21, 16, v0
v_add_u32 v20, v20, v21
s_mul_i32 s38, s3, 1536
v_add_u32 v20, s38, v20
s_lshl_b32 s38, s3, 3
v_mov_b32 v21, s38
v_lshlrev_b32 v22, 7, v37
v_lshlrev_b32 v23, 4, v36
v_add_u32 v22, v22, v23
s_lshl_b32 s91, s4, 10
s_add_u32 s91, s91, 65536
v_lshlrev_b32 v23, 10, v36
v_add_u32 v23, v23, v38
s_lshl_b32 s92, s5, 13
s_lshl_b32 s38, s6, 7
s_add_u32 s92, s92, s38
s_add_u32 s92, s92, 65536
v_cmp_ne_u32 s[98:99], s6, v36
v_lshrrev_b32 v24, 5, v0
v_lshlrev_b32 v24, 2, v24
v_and_b32 v25, 8, v0
v_cmp_ne_u32 vcc, 0, v25
s_nop 1
v_cndmask_b32 v24, v24, v25, vcc
v_add_u32 v24, s3, v24
v_lshlrev_b32 v25, 4, v24
v_lshlrev_b32 v26, 1, v37
v_add_u32 v25, v25, v26
v_bfe_u32 v26, v0, 4, 1
v_add_u32 v25, v25, v26
v_lshrrev_b32 v26, 2, v25
v_lshlrev_b32 v26, 14, v26
v_and_b32 v27, 3, v25
v_lshlrev_b32 v27, 4, v27
v_add_u32 v26, v26, v27
v_min_u32 v25, 159, v25
v_lshlrev_b32 v25, 4, v25
v_and_b32 v27, 40, v0
v_cmp_eq_u32 vcc, 40, v27
v_cmp_lt_u32 s[96:97], 9, v24
s_or_b64 vcc, vcc, s[96:97]
v_mov_b32 v27, 0x40000000
s_nop 0
v_cndmask_b32 v26, v26, v27, vcc
s_lshl_b32 s93, s4, 6
s_add_u32 s93, s93, 1048576
v_mul_u32_u24 v24, 24, v36
v_add_u32 v24, v24, v37
v_lshlrev_b32 v24, 2, v24
v_add_u32 v24, 8320, v24
v_lshlrev_b32 v39, 4, v0
s_mov_b32 s95, 0xffffff00
s_mov_b32 s100, 0x0c0c0400
s_mov_b32 s101, 0x0c040100
s_mov_b32 s59, 0x04020100
v_mul_u32_u24 v34, 1280, v36
v_add_u32 v34, v34, v38
s_lshl_b32 s38, s3, 7
v_add_u32 v34, s38, v34
s_cmp_ge_u32 s3, 2
s_cselect_b32 s38, 0x40000000, 0
v_add_u32 v35, s38, v34
s_mul_i32 s56, s4, 30720
s_add_u32 s57, s56, 10240
s_add_u32 s58, s56, 20480
v_mov_b32 v2, 0xff800000
v_mov_b32 v3, 0
s_waitcnt vmcnt(5)
s_add_u32 s39, s7, 196608
buffer_load_dwordx4 v[80:83], v1, s[8:11], s39 offen offset:0 nt
s_waitcnt vmcnt(5)
buffer_load_dwordx4 v[84:87], v1, s[8:11], s39 offen offset:128 nt
s_waitcnt vmcnt(5)
buffer_load_dwordx4 v[88:91], v1, s[8:11], s39 offen offset:256 nt
s_waitcnt vmcnt(5)
s_add_u32 s39, s7, 294912
buffer_load_dwordx4 v[92:95], v1, s[8:11], s39 offen offset:0 nt
s_waitcnt vmcnt(5)
buffer_load_dwordx4 v[96:99], v1, s[8:11], s39 offen offset:128 nt
s_waitcnt vmcnt(5)
buffer_load_dwordx4 v[100:103], v1, s[8:11], s39 offen offset:256 nt
s_waitcnt vmcnt(5)
s_add_u32 s39, s7, 393216
buffer_load_dwordx4 v[104:107], v1, s[8:11], s39 offen offset:0 nt
s_waitcnt vmcnt(5)
buffer_load_dwordx4 v[108:111], v1, s[8:11], s39 offen offset:128 nt
s_waitcnt vmcnt(5)
buffer_load_dwordx4 v[112:115], v1, s[8:11], s39 offen offset:256 nt
s_waitcnt vmcnt(5)
s_add_u32 s39, s7, 491520
buffer_load_dwordx4 v[116:119], v1, s[8:11], s39 offen offset:0 nt
s_waitcnt vmcnt(5)
buffer_load_dwordx4 v[120:123], v1, s[8:11], s39 offen offset:128 nt
s_waitcnt vmcnt(5)
buffer_load_dwordx4 v[124:127], v1, s[8:11], s39 offen offset:256 nt
s_waitcnt vmcnt(5)
s_add_u32 s39, s7, 589824
buffer_load_dwordx4 v[128:131], v1, s[8:11], s39 offen offset:0 nt
s_waitcnt vmcnt(5)
buffer_load_dwordx4 v[132:135], v1, s[8:11], s39 offen offset:128 nt
s_waitcnt vmcnt(5)
buffer_load_dwordx4 v[136:139], v1, s[8:11], s39 offen offset:256 nt
s_waitcnt vmcnt(5)
s_add_u32 s39, s7, 688128
buffer_load_dwordx4 v[140:143], v1, s[8:11], s39 offen offset:0 nt
s_waitcnt vmcnt(5)
buffer_load_dwordx4 v[144:147], v1, s[8:11], s39 offen offset:128 nt
s_waitcnt vmcnt(5)
buffer_load_dwordx4 v[148:151], v1, s[8:11], s39 offen offset:256 nt
s_waitcnt vmcnt(5)
s_add_u32 s39, s7, 786432
buffer_load_dwordx4 v[152:155], v1, s[8:11], s39 offen offset:0 nt
s_waitcnt vmcnt(5)
buffer_load_dwordx4 v[156:159], v1, s[8:11], s39 offen offset:128 nt
s_waitcnt vmcnt(5)
buffer_load_dwordx4 v[160:163], v1, s[8:11], s39 offen offset:256 nt
s_waitcnt vmcnt(5)
s_add_u32 s39, s7, 884736
buffer_load_dwordx4 v[164:167], v1, s[8:11], s39 offen offset:0 nt
s_waitcnt vmcnt(5)
buffer_load_dwordx4 v[168:171], v1, s[8:11], s39 offen offset:128 nt
s_waitcnt vmcnt(5)
buffer_load_dwordx4 v[172:175], v1, s[8:11], s39 offen offset:256 nt
s_waitcnt vmcnt(5)
s_add_u32 s39, s7, 983040
buffer_load_dwordx4 v[176:179], v1, s[8:11], s39 offen offset:0 nt
s_waitcnt vmcnt(5)
buffer_load_dwordx4 v[180:183], v1, s[8:11], s39 offen offset:128 nt
s_waitcnt vmcnt(5)
buffer_load_dwordx4 v[184:187], v1, s[8:11], s39 offen offset:256 nt
s_waitcnt vmcnt(5)
s_add_u32 s39, s7, 1081344
buffer_load_dwordx4 v[188:191], v1, s[8:11], s39 offen offset:0 nt
s_waitcnt vmcnt(5)
buffer_load_dwordx4 v[192:195], v1, s[8:11], s39 offen offset:128 nt
s_waitcnt vmcnt(5)
buffer_load_dwordx4 v[196:199], v1, s[8:11], s39 offen offset:256 nt
s_waitcnt vmcnt(5)
s_add_u32 s39, s7, 1179648
buffer_load_dwordx4 v[200:203], v1, s[8:11], s39 offen offset:0 nt
s_waitcnt vmcnt(5)
buffer_load_dwordx4 v[204:207], v1, s[8:11], s39 offen offset:128 nt
s_waitcnt vmcnt(5)
buffer_load_dwordx4 v[208:211], v1, s[8:11], s39 offen offset:256 nt
s_waitcnt vmcnt(5)
s_add_u32 s39, s7, 1277952
buffer_load_dwordx4 v[212:215], v1, s[8:11], s39 offen offset:0 nt
s_waitcnt lgkmcnt(0)
s_add_u32 s63, s63, 0x9E3779B9
s_and_b32 s94, s63, 0xff
v_mov_b32 v27, s94
s_mul_i32 s94, s94, 0x01010101
s_memrealtime s[88:89]
v_mov_b32 v255, 720
s_waitcnt lgkmcnt(0)
v_mov_b32 v254, s88
ds_write_b64 v21, v[254:255] offset:15872
s_waitcnt lgkmcnt(0)
s_barrier
ds_read_b128 v[8:11], v38 offset:2816
ds_read_b128 v[12:15], v38 offset:2944
ds_read_b128 v[16:19], v38 offset:3072
ds_read_b32 v33, v3 offset:15936
s_waitcnt lgkmcnt(0)
v_readfirstlane_b32 s34, v33
v_dot2_f32_bf16 v32, v56, v8, 0
v_dot2_f32_bf16 v32, v57, v9, v32
v_dot2_f32_bf16 v32, v58, v10, v32
v_dot2_f32_bf16 v32, v59, v11, v32
v_dot2_f32_bf16 v32, v60, v12, v32
v_dot2_f32_bf16 v32, v61, v13, v32
v_dot2_f32_bf16 v32, v62, v14, v32
v_dot2_f32_bf16 v32, v63, v15, v32
v_dot2_f32_bf16 v32, v64, v16, v32
v_dot2_f32_bf16 v32, v65, v17, v32
v_dot2_f32_bf16 v32, v66, v18, v32
v_dot2_f32_bf16 v32, v67, v19, v32
s_nop 2
v_add_f32_dpp v33, v32, v32 quad_perm:[1,0,3,2] row_mask:0xf bank_mask:0xf
s_nop 1
v_add_f32_dpp v33, v33, v33 quad_perm:[2,3,0,1] row_mask:0xf bank_mask:0xf
s_nop 1
v_add_f32_dpp v33, v33, v33 row_half_mirror row_mask:0xf bank_mask:0xf
v_cvt_pk_bf16_f32 v33, v33, v33
v_and_b32 v33, s60, v33
v_mul_f32 v33, s61, v33
v_cvt_pk_bf16_f32 v33, v33, v33
v_and_b32 v40, s60, v33
v_max_f32 v2, v2, v40
s_waitcnt vmcnt(5)
buffer_load_dwordx4 v[216:219], v1, s[8:11], s39 offen offset:128 nt
s_memrealtime s[88:89]
ds_read_b64 v[252:253], v21 offset:15904
v_dot2_f32_bf16 v32, v68, v8, 0
v_dot2_f32_bf16 v32, v69, v9, v32
v_dot2_f32_bf16 v32, v70, v10, v32
v_dot2_f32_bf16 v32, v71, v11, v32
v_dot2_f32_bf16 v32, v72, v12, v32
v_dot2_f32_bf16 v32, v73, v13, v32
v_dot2_f32_bf16 v32, v74, v14, v32
v_dot2_f32_bf16 v32, v75, v15, v32
v_dot2_f32_bf16 v32, v76, v16, v32
v_dot2_f32_bf16 v32, v77, v17, v32
v_dot2_f32_bf16 v32, v78, v18, v32
v_dot2_f32_bf16 v32, v79, v19, v32
s_nop 2
v_add_f32_dpp v33, v32, v32 quad_perm:[1,0,3,2] row_mask:0xf bank_mask:0xf
s_nop 1
v_add_f32_dpp v33, v33, v33 quad_perm:[2,3,0,1] row_mask:0xf bank_mask:0xf
s_nop 1
v_add_f32_dpp v33, v33, v33 row_half_mirror row_mask:0xf bank_mask:0xf
v_cvt_pk_bf16_f32 v33, v33, v33
v_and_b32 v33, s60, v33
v_mul_f32 v33, s61, v33
v_cvt_pk_bf16_f32 v33, v33, v33
v_and_b32 v41, s60, v33
v_max_f32 v2, v2, v41
s_waitcnt vmcnt(6)
s_waitcnt vmcnt(5)
buffer_load_dwordx4 v[220:223], v1, s[8:11], s39 offen offset:256 nt
s_waitcnt lgkmcnt(0)
v_mov_b32 v255, 736
v_mul_u32_u24 v253, v255, v253
v_mov_b32 v254, s88
v_lshrrev_b32 v253, 12, v253
ds_write_b64 v21, v[254:255] offset:15872
v_add_u32 v253, v253, v252
v_sub_u32 v253, v254, v253
v_cmp_lt_i32 vcc, 0, v253
v_dot2_f32_bf16 v32, v80, v8, 0
v_dot2_f32_bf16 v32, v81, v9, v32
v_dot2_f32_bf16 v32, v82, v10, v32
v_dot2_f32_bf16 v32, v83, v11, v32
v_dot2_f32_bf16 v32, v84, v12, v32
v_dot2_f32_bf16 v32, v85, v13, v32
v_dot2_f32_bf16 v32, v86, v14, v32
v_dot2_f32_bf16 v32, v87, v15, v32
v_dot2_f32_bf16 v32, v88, v16, v32
v_dot2_f32_bf16 v32, v89, v17, v32
v_dot2_f32_bf16 v32, v90, v18, v32
v_dot2_f32_bf16 v32, v91, v19, v32
s_nop 2
v_add_f32_dpp v33, v32, v32 quad_perm:[1,0,3,2] row_mask:0xf bank_mask:0xf
s_nop 1
v_add_f32_dpp v33, v33, v33 quad_perm:[2,3,0,1] row_mask:0xf bank_mask:0xf
s_nop 1
v_add_f32_dpp v33, v33, v33 row_half_mirror row_mask:0xf bank_mask:0xf
v_cvt_pk_bf16_f32 v33, v33, v33
v_and_b32 v33, s60, v33
v_mul_f32 v33, s61, v33
v_cvt_pk_bf16_f32 v33, v33, v33
v_and_b32 v42, s60, v33
v_max_f32 v2, v2, v42
s_waitcnt vmcnt(6)
s_cbranch_vccnz L_fb42
s_waitcnt vmcnt(4)
L_fb42:
s_add_u32 s39, s7, 1376256
buffer_load_dwordx4 v[224:227], v1, s[8:11], s39 offen offset:0 nt
v_dot2_f32_bf16 v32, v92, v8, 0
v_dot2_f32_bf16 v32, v93, v9, v32
v_dot2_f32_bf16 v32, v94, v10, v32
v_dot2_f32_bf16 v32, v95, v11, v32
v_dot2_f32_bf16 v32, v96, v12, v32
v_dot2_f32_bf16 v32, v97, v13, v32
v_dot2_f32_bf16 v32, v98, v14, v32
v_dot2_f32_bf16 v32, v99, v15, v32
v_dot2_f32_bf16 v32, v100, v16, v32
v_dot2_f32_bf16 v32, v101, v17, v32
v_dot2_f32_bf16 v32, v102, v18, v32
v_dot2_f32_bf16 v32, v103, v19, v32
s_nop 2
v_add_f32_dpp v33, v32, v32 quad_perm:[1,0,3,2] row_mask:0xf bank_mask:0xf
s_nop 1
v_add_f32_dpp v33, v33, v33 quad_perm:[2,3,0,1] row_mask:0xf bank_mask:0xf
s_nop 1
v_add_f32_dpp v33, v33, v33 row_half_mirror row_mask:0xf bank_mask:0xf
v_cvt_pk_bf16_f32 v33, v33, v33
v_and_b32 v33, s60, v33
v_mul_f32 v33, s61, v33
v_cvt_pk_bf16_f32 v33, v33, v33
v_and_b32 v43, s60, v33
v_max_f32 v2, v2, v43
s_waitcnt vmcnt(6)
s_cbranch_vccnz L_fb43
s_waitcnt vmcnt(4)
L_fb43:
buffer_load_dwordx4 v[228:231], v1, s[8:11], s39 offen offset:128 nt
v_dot2_f32_bf16 v32, v104, v8, 0
v_dot2_f32_bf16 v32, v105, v9, v32
v_dot2_f32_bf16 v32, v106, v10, v32
v_dot2_f32_bf16 v32, v107, v11, v32
v_dot2_f32_bf16 v32, v108, v12, v32
v_dot2_f32_bf16 v32, v109, v13, v32
v_dot2_f32_bf16 v32, v110, v14, v32
v_dot2_f32_bf16 v32, v111, v15, v32
v_dot2_f32_bf16 v32, v112, v16, v32
v_dot2_f32_bf16 v32, v113, v17, v32
v_dot2_f32_bf16 v32, v114, v18, v32
v_dot2_f32_bf16 v32, v115, v19, v32
s_nop 2
v_add_f32_dpp v33, v32, v32 quad_perm:[1,0,3,2] row_mask:0xf bank_mask:0xf
s_nop 1
v_add_f32_dpp v33, v33, v33 quad_perm:[2,3,0,1] row_mask:0xf bank_mask:0xf
s_nop 1
v_add_f32_dpp v33, v33, v33 row_half_mirror row_mask:0xf bank_mask:0xf
v_cvt_pk_bf16_f32 v33, v33, v33
v_and_b32 v33, s60, v33
v_mul_f32 v33, s61, v33
v_cvt_pk_bf16_f32 v33, v33, v33
v_and_b32 v44, s60, v33
v_max_f32 v2, v2, v44
s_waitcnt vmcnt(6)
s_cbranch_vccnz L_fb44
s_waitcnt vmcnt(4)
L_fb44:
buffer_load_dwordx4 v[232:235], v1, s[8:11], s39 offen offset:256 nt
v_dot2_f32_bf16 v32, v116, v8, 0
v_dot2_f32_bf16 v32, v117, v9, v32
v_dot2_f32_bf16 v32, v118, v10, v32
v_dot2_f32_bf16 v32, v119, v11, v32
v_dot2_f32_bf16 v32, v120, v12, v32
v_dot2_f32_bf16 v32, v121, v13, v32
v_dot2_f32_bf16 v32, v122, v14, v32
v_dot2_f32_bf16 v32, v123, v15, v32
v_dot2_f32_bf16 v32, v124, v16, v32
v_dot2_f32_bf16 v32, v125, v17, v32
v_dot2_f32_bf16 v32, v126, v18, v32
v_dot2_f32_bf16 v32, v127, v19, v32
s_nop 2
v_add_f32_dpp v33, v32, v32 quad_perm:[1,0,3,2] row_mask:0xf bank_mask:0xf
s_nop 1
v_add_f32_dpp v33, v33, v33 quad_perm:[2,3,0,1] row_mask:0xf bank_mask:0xf
s_nop 1
v_add_f32_dpp v33, v33, v33 row_half_mirror row_mask:0xf bank_mask:0xf
v_cvt_pk_bf16_f32 v33, v33, v33
v_and_b32 v33, s60, v33
v_mul_f32 v33, s61, v33
v_cvt_pk_bf16_f32 v33, v33, v33
v_and_b32 v45, s60, v33
v_max_f32 v2, v2, v45
s_waitcnt vmcnt(6)
s_cbranch_vccnz L_fb45
s_waitcnt vmcnt(4)
L_fb45:
s_add_u32 s39, s7, 1474560
buffer_load_dwordx4 v[236:239], v1, s[8:11], s39 offen offset:0 nt
v_dot2_f32_bf16 v32, v128, v8, 0
v_dot2_f32_bf16 v32, v129, v9, v32
v_dot2_f32_bf16 v32, v130, v10, v32
v_dot2_f32_bf16 v32, v131, v11, v32
v_dot2_f32_bf16 v32, v132, v12, v32
v_dot2_f32_bf16 v32, v133, v13, v32
v_dot2_f32_bf16 v32, v134, v14, v32
v_dot2_f32_bf16 v32, v135, v15, v32
v_dot2_f32_bf16 v32, v136, v16, v32
v_dot2_f32_bf16 v32, v137, v17, v32
v_dot2_f32_bf16 v32, v138, v18, v32
v_dot2_f32_bf16 v32, v139, v19, v32
s_nop 2
v_add_f32_dpp v33, v32, v32 quad_perm:[1,0,3,2] row_mask:0xf bank_mask:0xf
s_nop 1
v_add_f32_dpp v33, v33, v33 quad_perm:[2,3,0,1] row_mask:0xf bank_mask:0xf
s_nop 1
v_add_f32_dpp v33, v33, v33 row_half_mirror row_mask:0xf bank_mask:0xf
v_cvt_pk_bf16_f32 v33, v33, v33
v_and_b32 v33, s60, v33
v_mul_f32 v33, s61, v33
v_cvt_pk_bf16_f32 v33, v33, v33
v_and_b32 v46, s60, v33
v_max_f32 v2, v2, v46
s_waitcnt vmcnt(6)
s_cbranch_vccnz L_fb46
s_waitcnt vmcnt(4)
L_fb46:
buffer_load_dwordx4 v[240:243], v1, s[8:11], s39 offen offset:128 nt
s_memrealtime s[88:89]
ds_read_b64 v[252:253], v21 offset:15904
v_dot2_f32_bf16 v32, v140, v8, 0
v_dot2_f32_bf16 v32, v141, v9, v32
v_dot2_f32_bf16 v32, v142, v10, v32
v_dot2_f32_bf16 v32, v143, v11, v32
v_dot2_f32_bf16 v32, v144, v12, v32
v_dot2_f32_bf16 v32, v145, v13, v32
v_dot2_f32_bf16 v32, v146, v14, v32
v_dot2_f32_bf16 v32, v147, v15, v32
v_dot2_f32_bf16 v32, v148, v16, v32
v_dot2_f32_bf16 v32, v149, v17, v32
v_dot2_f32_bf16 v32, v150, v18, v32
v_dot2_f32_bf16 v32, v151, v19, v32
s_nop 2
v_add_f32_dpp v33, v32, v32 quad_perm:[1,0,3,2] row_mask:0xf bank_mask:0xf
s_nop 1
v_add_f32_dpp v33, v33, v33 quad_perm:[2,3,0,1] row_mask:0xf bank_mask:0xf
s_nop 1
v_add_f32_dpp v33, v33, v33 row_half_mirror row_mask:0xf bank_mask:0xf
v_cvt_pk_bf16_f32 v33, v33, v33
v_and_b32 v33, s60, v33
v_mul_f32 v33, s61, v33
v_cvt_pk_bf16_f32 v33, v33, v33
v_and_b32 v47, s60, v33
v_max_f32 v2, v2, v47
s_waitcnt vmcnt(6)
s_cbranch_vccnz L_fb47
s_waitcnt vmcnt(4)
L_fb47:
buffer_load_dwordx4 v[244:247], v1, s[8:11], s39 offen offset:256 nt
s_waitcnt lgkmcnt(0)
v_mov_b32 v255, 830
v_mul_u32_u24 v253, v255, v253
v_mov_b32 v254, s88
v_lshrrev_b32 v253, 12, v253
ds_write_b64 v21, v[254:255] offset:15872
v_add_u32 v253, v253, v252
v_sub_u32 v253, v254, v253
v_cmp_lt_i32 vcc, 0, v253
v_dot2_f32_bf16 v32, v152, v8, 0
v_dot2_f32_bf16 v32, v153, v9, v32
v_dot2_f32_bf16 v32, v154, v10, v32
v_dot2_f32_bf16 v32, v155, v11, v32
v_dot2_f32_bf16 v32, v156, v12, v32
v_dot2_f32_bf16 v32, v157, v13, v32
v_dot2_f32_bf16 v32, v158, v14, v32
v_dot2_f32_bf16 v32, v159, v15, v32
v_dot2_f32_bf16 v32, v160, v16, v32
v_dot2_f32_bf16 v32, v161, v17, v32
v_dot2_f32_bf16 v32, v162, v18, v32
v_dot2_f32_bf16 v32, v163, v19, v32
s_nop 2
v_add_f32_dpp v33, v32, v32 quad_perm:[1,0,3,2] row_mask:0xf bank_mask:0xf
s_nop 1
v_add_f32_dpp v33, v33, v33 quad_perm:[2,3,0,1] row_mask:0xf bank_mask:0xf
s_nop 1
v_add_f32_dpp v33, v33, v33 row_half_mirror row_mask:0xf bank_mask:0xf
v_cvt_pk_bf16_f32 v33, v33, v33
v_and_b32 v33, s60, v33
v_mul_f32 v33, s61, v33
v_cvt_pk_bf16_f32 v33, v33, v33
v_and_b32 v48, s60, v33
v_max_f32 v2, v2, v48
s_waitcnt vmcnt(6)
s_cbranch_vccnz L_fb48
s_waitcnt vmcnt(4)
L_fb48:
s_add_u32 s39, s7, 1572864
buffer_load_dwordx4 v[248:251], v1, s[8:11], s39 offen offset:0 nt
v_dot2_f32_bf16 v32, v164, v8, 0
v_dot2_f32_bf16 v32, v165, v9, v32
v_dot2_f32_bf16 v32, v166, v10, v32
v_dot2_f32_bf16 v32, v167, v11, v32
v_dot2_f32_bf16 v32, v168, v12, v32
v_dot2_f32_bf16 v32, v169, v13, v32
v_dot2_f32_bf16 v32, v170, v14, v32
v_dot2_f32_bf16 v32, v171, v15, v32
v_dot2_f32_bf16 v32, v172, v16, v32
v_dot2_f32_bf16 v32, v173, v17, v32
v_dot2_f32_bf16 v32, v174, v18, v32
v_dot2_f32_bf16 v32, v175, v19, v32
s_nop 2
v_add_f32_dpp v33, v32, v32 quad_perm:[1,0,3,2] row_mask:0xf bank_mask:0xf
s_nop 1
v_add_f32_dpp v33, v33, v33 quad_perm:[2,3,0,1] row_mask:0xf bank_mask:0xf
s_nop 1
v_add_f32_dpp v33, v33, v33 row_half_mirror row_mask:0xf bank_mask:0xf
v_cvt_pk_bf16_f32 v33, v33, v33
v_and_b32 v33, s60, v33
v_mul_f32 v33, s61, v33
v_cvt_pk_bf16_f32 v33, v33, v33
v_and_b32 v49, s60, v33
v_max_f32 v2, v2, v49
s_waitcnt vmcnt(6)
s_cbranch_vccnz L_fb49
s_waitcnt vmcnt(4)
L_fb49:
buffer_load_dwordx4 v[104:107], v1, s[8:11], s39 offen offset:128 nt
v_dot2_f32_bf16 v32, v176, v8, 0
v_dot2_f32_bf16 v32, v177, v9, v32
v_dot2_f32_bf16 v32, v178, v10, v32
v_dot2_f32_bf16 v32, v179, v11, v32
v_dot2_f32_bf16 v32, v180, v12, v32
v_dot2_f32_bf16 v32, v181, v13, v32
v_dot2_f32_bf16 v32, v182, v14, v32
v_dot2_f32_bf16 v32, v183, v15, v32
v_dot2_f32_bf16 v32, v184, v16, v32
v_dot2_f32_bf16 v32, v185, v17, v32
v_dot2_f32_bf16 v32, v186, v18, v32
v_dot2_f32_bf16 v32, v187, v19, v32
s_nop 2
v_add_f32_dpp v33, v32, v32 quad_perm:[1,0,3,2] row_mask:0xf bank_mask:0xf
s_nop 1
v_add_f32_dpp v33, v33, v33 quad_perm:[2,3,0,1] row_mask:0xf bank_mask:0xf
s_nop 1
v_add_f32_dpp v33, v33, v33 row_half_mirror row_mask:0xf bank_mask:0xf
v_cvt_pk_bf16_f32 v33, v33, v33
v_and_b32 v33, s60, v33
v_mul_f32 v33, s61, v33
v_cvt_pk_bf16_f32 v33, v33, v33
v_and_b32 v50, s60, v33
v_max_f32 v2, v2, v50
s_waitcnt vmcnt(6)
s_cbranch_vccnz L_fb50
s_waitcnt vmcnt(4)
L_fb50:
buffer_load_dwordx4 v[108:111], v1, s[8:11], s39 offen offset:256 nt
v_dot2_f32_bf16 v32, v188, v8, 0
v_dot2_f32_bf16 v32, v189, v9, v32
v_dot2_f32_bf16 v32, v190, v10, v32
v_dot2_f32_bf16 v32, v191, v11, v32
v_dot2_f32_bf16 v32, v192, v12, v32
v_dot2_f32_bf16 v32, v193, v13, v32
v_dot2_f32_bf16 v32, v194, v14, v32
v_dot2_f32_bf16 v32, v195, v15, v32
v_dot2_f32_bf16 v32, v196, v16, v32
v_dot2_f32_bf16 v32, v197, v17, v32
v_dot2_f32_bf16 v32, v198, v18, v32
v_dot2_f32_bf16 v32, v199, v19, v32
s_nop 2
v_add_f32_dpp v33, v32, v32 quad_perm:[1,0,3,2] row_mask:0xf bank_mask:0xf
s_nop 1
v_add_f32_dpp v33, v33, v33 quad_perm:[2,3,0,1] row_mask:0xf bank_mask:0xf
s_nop 1
v_add_f32_dpp v33, v33, v33 row_half_mirror row_mask:0xf bank_mask:0xf
v_cvt_pk_bf16_f32 v33, v33, v33
v_and_b32 v33, s60, v33
v_mul_f32 v33, s61, v33
v_cvt_pk_bf16_f32 v33, v33, v33
v_and_b32 v51, s60, v33
v_max_f32 v2, v2, v51
s_waitcnt vmcnt(6)
s_cbranch_vccnz L_fb51
s_waitcnt vmcnt(4)
L_fb51:
s_add_u32 s39, s7, 1671168
buffer_load_dwordx4 v[112:115], v1, s[8:11], s39 offen offset:0 nt
v_dot2_f32_bf16 v32, v200, v8, 0
v_dot2_f32_bf16 v32, v201, v9, v32
v_dot2_f32_bf16 v32, v202, v10, v32
v_dot2_f32_bf16 v32, v203, v11, v32
v_dot2_f32_bf16 v32, v204, v12, v32
v_dot2_f32_bf16 v32, v205, v13, v32
v_dot2_f32_bf16 v32, v206, v14, v32
v_dot2_f32_bf16 v32, v207, v15, v32
v_dot2_f32_bf16 v32, v208, v16, v32
v_dot2_f32_bf16 v32, v209, v17, v32
v_dot2_f32_bf16 v32, v210, v18, v32
v_dot2_f32_bf16 v32, v211, v19, v32
s_nop 2
v_add_f32_dpp v33, v32, v32 quad_perm:[1,0,3,2] row_mask:0xf bank_mask:0xf
s_nop 1
v_add_f32_dpp v33, v33, v33 quad_perm:[2,3,0,1] row_mask:0xf bank_mask:0xf
s_nop 1
v_add_f32_dpp v33, v33, v33 row_half_mirror row_mask:0xf bank_mask:0xf
v_cvt_pk_bf16_f32 v33, v33, v33
v_and_b32 v33, s60, v33
v_mul_f32 v33, s61, v33
v_cvt_pk_bf16_f32 v33, v33, v33
v_and_b32 v52, s60, v33
v_max_f32 v2, v2, v52
s_waitcnt vmcnt(6)
s_cbranch_vccnz L_fb52
s_waitcnt vmcnt(4)
L_fb52:
buffer_load_dwordx4 v[116:119], v1, s[8:11], s39 offen offset:128 nt
s_memrealtime s[88:89]
ds_read_b64 v[252:253], v21 offset:15904
v_dot2_f32_bf16 v32, v212, v8, 0
v_dot2_f32_bf16 v32, v213, v9, v32
v_dot2_f32_bf16 v32, v214, v10, v32
v_dot2_f32_bf16 v32, v215, v11, v32
v_dot2_f32_bf16 v32, v216, v12, v32
v_dot2_f32_bf16 v32, v217, v13, v32
v_dot2_f32_bf16 v32, v218, v14, v32
v_dot2_f32_bf16 v32, v219, v15, v32
v_dot2_f32_bf16 v32, v220, v16, v32
v_dot2_f32_bf16 v32, v221, v17, v32
v_dot2_f32_bf16 v32, v222, v18, v32
v_dot2_f32_bf16 v32, v223, v19, v32
s_nop 2
v_add_f32_dpp v33, v32, v32 quad_perm:[1,0,3,2] row_mask:0xf bank_mask:0xf
s_nop 1
v_add_f32_dpp v33, v33, v33 quad_perm:[2,3,0,1] row_mask:0xf bank_mask:0xf
s_nop 1
v_add_f32_dpp v33, v33, v33 row_half_mirror row_mask:0xf bank_mask:0xf
v_cvt_pk_bf16_f32 v33, v33, v33
v_and_b32 v33, s60, v33
v_mul_f32 v33, s61, v33
v_cvt_pk_bf16_f32 v33, v33, v33
v_and_b32 v53, s60, v33
v_max_f32 v2, v2, v53
s_waitcnt vmcnt(6)
s_cbranch_vccnz L_fb53
s_waitcnt vmcnt(4)
L_fb53:
buffer_load_dwordx4 v[120:123], v1, s[8:11], s39 offen offset:256 nt
s_waitcnt lgkmcnt(0)
v_mov_b32 v255, 924
v_mul_u32_u24 v253, v255, v253
v_mov_b32 v254, s88
v_lshrrev_b32 v253, 12, v253
ds_write_b64 v21, v[254:255] offset:15872
v_add_u32 v253, v253, v252
v_sub_u32 v253, v254, v253
v_cmp_lt_i32 vcc, 0, v253
v_dot2_f32_bf16 v32, v224, v8, 0
v_dot2_f32_bf16 v32, v225, v9, v32
v_dot2_f32_bf16 v32, v226, v10, v32
v_dot2_f32_bf16 v32, v227, v11, v32
v_dot2_f32_bf16 v32, v228, v12, v32
v_dot2_f32_bf16 v32, v229, v13, v32
v_dot2_f32_bf16 v32, v230, v14, v32
v_dot2_f32_bf16 v32, v231, v15, v32
v_dot2_f32_bf16 v32, v232, v16, v32
v_dot2_f32_bf16 v32, v233, v17, v32
v_dot2_f32_bf16 v32, v234, v18, v32
v_dot2_f32_bf16 v32, v235, v19, v32
s_nop 2
v_add_f32_dpp v33, v32, v32 quad_perm:[1,0,3,2] row_mask:0xf bank_mask:0xf
s_nop 1
v_add_f32_dpp v33, v33, v33 quad_perm:[2,3,0,1] row_mask:0xf bank_mask:0xf
s_nop 1
v_add_f32_dpp v33, v33, v33 row_half_mirror row_mask:0xf bank_mask:0xf
v_cvt_pk_bf16_f32 v33, v33, v33
v_and_b32 v33, s60, v33
v_mul_f32 v33, s61, v33
v_cvt_pk_bf16_f32 v33, v33, v33
v_and_b32 v54, s60, v33
v_max_f32 v2, v2, v54
s_waitcnt vmcnt(6)
s_cbranch_vccnz L_fb54
s_waitcnt vmcnt(4)
L_fb54:
s_add_u32 s39, s7, 1769472
buffer_load_dwordx4 v[124:127], v1, s[8:11], s39 offen offset:0 nt
v_dot2_f32_bf16 v32, v236, v8, 0
v_dot2_f32_bf16 v32, v237, v9, v32
v_dot2_f32_bf16 v32, v238, v10, v32
v_dot2_f32_bf16 v32, v239, v11, v32
v_dot2_f32_bf16 v32, v240, v12, v32
v_dot2_f32_bf16 v32, v241, v13, v32
v_dot2_f32_bf16 v32, v242, v14, v32
v_dot2_f32_bf16 v32, v243, v15, v32
v_dot2_f32_bf16 v32, v244, v16, v32
v_dot2_f32_bf16 v32, v245, v17, v32
v_dot2_f32_bf16 v32, v246, v18, v32
v_dot2_f32_bf16 v32, v247, v19, v32
s_nop 2
v_add_f32_dpp v33, v32, v32 quad_perm:[1,0,3,2] row_mask:0xf bank_mask:0xf
s_nop 1
v_add_f32_dpp v33, v33, v33 quad_perm:[2,3,0,1] row_mask:0xf bank_mask:0xf
s_nop 1
v_add_f32_dpp v33, v33, v33 row_half_mirror row_mask:0xf bank_mask:0xf
v_cvt_pk_bf16_f32 v33, v33, v33
v_and_b32 v33, s60, v33
v_mul_f32 v33, s61, v33
v_cvt_pk_bf16_f32 v33, v33, v33
v_and_b32 v55, s60, v33
v_max_f32 v2, v2, v55
s_waitcnt vmcnt(6)
s_cbranch_vccnz L_fb55
s_waitcnt vmcnt(4)
L_fb55:
buffer_load_dwordx4 v[128:131], v1, s[8:11], s39 offen offset:128 nt
v_dot2_f32_bf16 v32, v248, v8, 0
v_dot2_f32_bf16 v32, v249, v9, v32
v_dot2_f32_bf16 v32, v250, v10, v32
v_dot2_f32_bf16 v32, v251, v11, v32
s_waitcnt vmcnt(6)
s_cbranch_vccnz L_fb56
s_waitcnt vmcnt(4)
L_fb56:
buffer_load_dwordx4 v[132:135], v1, s[8:11], s39 offen offset:256 nt
v_dot2_f32_bf16 v32, v104, v12, v32
v_dot2_f32_bf16 v32, v105, v13, v32
v_dot2_f32_bf16 v32, v106, v14, v32
v_dot2_f32_bf16 v32, v107, v15, v32
s_waitcnt vmcnt(6)
s_cbranch_vccnz L_fb57
s_waitcnt vmcnt(4)
L_fb57:
s_add_u32 s39, s7, 1867776
buffer_load_dwordx4 v[136:139], v1, s[8:11], s39 offen offset:0 nt
v_dot2_f32_bf16 v32, v108, v16, v32
v_dot2_f32_bf16 v32, v109, v17, v32
v_dot2_f32_bf16 v32, v110, v18, v32
v_dot2_f32_bf16 v32, v111, v19, v32
s_nop 2
v_add_f32_dpp v33, v32, v32 quad_perm:[1,0,3,2] row_mask:0xf bank_mask:0xf
s_nop 1
v_add_f32_dpp v33, v33, v33 quad_perm:[2,3,0,1] row_mask:0xf bank_mask:0xf
s_nop 1
v_add_f32_dpp v33, v33, v33 row_half_mirror row_mask:0xf bank_mask:0xf
v_cvt_pk_bf16_f32 v33, v33, v33
v_and_b32 v33, s60, v33
v_mul_f32 v33, s61, v33
v_cvt_pk_bf16_f32 v33, v33, v33
v_and_b32 v56, s60, v33
v_max_f32 v2, v2, v56
s_waitcnt vmcnt(6)
s_cbranch_vccnz L_fb58
s_waitcnt vmcnt(4)
L_fb58:
buffer_load_dwordx4 v[140:143], v1, s[8:11], s39 offen offset:128 nt
s_memrealtime s[88:89]
ds_read_b64 v[252:253], v21 offset:15904
v_dot2_f32_bf16 v32, v112, v8, 0
v_dot2_f32_bf16 v32, v113, v9, v32
v_dot2_f32_bf16 v32, v114, v10, v32
v_dot2_f32_bf16 v32, v115, v11, v32
s_waitcnt vmcnt(6)
s_cbranch_vccnz L_fb59
s_waitcnt vmcnt(4)
L_fb59:
buffer_load_dwordx4 v[144:147], v1, s[8:11], s39 offen offset:256 nt
s_waitcnt lgkmcnt(0)
v_mov_b32 v255, 1019
v_mul_u32_u24 v253, v255, v253
v_mov_b32 v254, s88
v_lshrrev_b32 v253, 12, v253
ds_write_b64 v21, v[254:255] offset:15872
v_add_u32 v253, v253, v252
v_sub_u32 v253, v254, v253
v_cmp_lt_i32 vcc, 0, v253
v_dot2_f32_bf16 v32, v116, v12, v32
v_dot2_f32_bf16 v32, v117, v13, v32
v_dot2_f32_bf16 v32, v118, v14, v32
v_dot2_f32_bf16 v32, v119, v15, v32
s_waitcnt vmcnt(6)
s_cbranch_vccnz L_fb60
s_waitcnt vmcnt(4)
L_fb60:
s_add_u32 s39, s7, 1966080
buffer_load_dwordx4 v[148:151], v1, s[8:11], s39 offen offset:0 nt
v_dot2_f32_bf16 v32, v120, v16, v32
v_dot2_f32_bf16 v32, v121, v17, v32
v_dot2_f32_bf16 v32, v122, v18, v32
v_dot2_f32_bf16 v32, v123, v19, v32
s_nop 2
v_add_f32_dpp v33, v32, v32 quad_perm:[1,0,3,2] row_mask:0xf bank_mask:0xf
s_nop 1
v_add_f32_dpp v33, v33, v33 quad_perm:[2,3,0,1] row_mask:0xf bank_mask:0xf
s_nop 1
v_add_f32_dpp v33, v33, v33 row_half_mirror row_mask:0xf bank_mask:0xf
v_cvt_pk_bf16_f32 v33, v33, v33
v_and_b32 v33, s60, v33
v_mul_f32 v33, s61, v33
v_cvt_pk_bf16_f32 v33, v33, v33
v_and_b32 v57, s60, v33
v_max_f32 v2, v2, v57
s_waitcnt vmcnt(6)
s_cbranch_vccnz L_fb61
s_waitcnt vmcnt(4)
L_fb61:
buffer_load_dwordx4 v[152:155], v1, s[8:11], s39 offen offset:128 nt
v_dot2_f32_bf16 v32, v124, v8, 0
v_dot2_f32_bf16 v32, v125, v9, v32
v_dot2_f32_bf16 v32, v126, v10, v32
v_dot2_f32_bf16 v32, v127, v11, v32
s_waitcnt vmcnt(6)
s_cbranch_vccnz L_fb62
s_waitcnt vmcnt(4)
L_fb62:
buffer_load_dwordx4 v[156:159], v1, s[8:11], s39 offen offset:256 nt
v_dot2_f32_bf16 v32, v128, v12, v32
v_dot2_f32_bf16 v32, v129, v13, v32
v_dot2_f32_bf16 v32, v130, v14, v32
v_dot2_f32_bf16 v32, v131, v15, v32
s_waitcnt vmcnt(6)
s_cbranch_vccnz L_fb63
s_waitcnt vmcnt(4)
L_fb63:
s_add_u32 s39, s7, 2064384
buffer_load_dwordx4 v[160:163], v1, s[8:11], s39 offen offset:0 nt
v_dot2_f32_bf16 v32, v132, v16, v32
v_dot2_f32_bf16 v32, v133, v17, v32
v_dot2_f32_bf16 v32, v134, v18, v32
v_dot2_f32_bf16 v32, v135, v19, v32
s_nop 2
v_add_f32_dpp v33, v32, v32 quad_perm:[1,0,3,2] row_mask:0xf bank_mask:0xf
s_nop 1
v_add_f32_dpp v33, v33, v33 quad_perm:[2,3,0,1] row_mask:0xf bank_mask:0xf
s_nop 1
v_add_f32_dpp v33, v33, v33 row_half_mirror row_mask:0xf bank_mask:0xf
v_cvt_pk_bf16_f32 v33, v33, v33
v_and_b32 v33, s60, v33
v_mul_f32 v33, s61, v33
v_cvt_pk_bf16_f32 v33, v33, v33
v_and_b32 v58, s60, v33
v_max_f32 v2, v2, v58
s_waitcnt vmcnt(6)
s_cbranch_vccnz L_fb64
s_waitcnt vmcnt(4)
L_fb64:
buffer_load_dwordx4 v[164:167], v1, s[8:11], s39 offen offset:128 nt
s_memrealtime s[88:89]
ds_read_b64 v[252:253], v21 offset:15904
v_dot2_f32_bf16 v32, v136, v8, 0
v_dot2_f32_bf16 v32, v137, v9, v32
v_dot2_f32_bf16 v32, v138, v10, v32
v_dot2_f32_bf16 v32, v139, v11, v32
s_waitcnt vmcnt(6)
s_cbranch_vccnz L_fb65
s_waitcnt vmcnt(4)
L_fb65:
buffer_load_dwordx4 v[168:171], v1, s[8:11], s39 offen offset:256 nt
s_waitcnt lgkmcnt(0)
v_mov_b32 v255, 1113
v_mul_u32_u24 v253, v255, v253
v_mov_b32 v254, s88
v_lshrrev_b32 v253, 12, v253
ds_write_b64 v21, v[254:255] offset:15872
v_add_u32 v253, v253, v252
v_sub_u32 v253, v254, v253
v_cmp_lt_i32 vcc, 0, v253
v_dot2_f32_bf16 v32, v140, v12, v32
v_dot2_f32_bf16 v32, v141, v13, v32
v_dot2_f32_bf16 v32, v142, v14, v32
v_dot2_f32_bf16 v32, v143, v15, v32
s_waitcnt vmcnt(6)
s_cbranch_vccnz L_fb66
s_waitcnt vmcnt(4)
L_fb66:
s_add_u32 s39, s7, 2162688
buffer_load_dwordx4 v[172:175], v1, s[8:11], s39 offen offset:0 nt
v_dot2_f32_bf16 v32, v144, v16, v32
v_dot2_f32_bf16 v32, v145, v17, v32
v_dot2_f32_bf16 v32, v146, v18, v32
v_dot2_f32_bf16 v32, v147, v19, v32
s_nop 2
v_add_f32_dpp v33, v32, v32 quad_perm:[1,0,3,2] row_mask:0xf bank_mask:0xf
s_nop 1
v_add_f32_dpp v33, v33, v33 quad_perm:[2,3,0,1] row_mask:0xf bank_mask:0xf
s_nop 1
v_add_f32_dpp v33, v33, v33 row_half_mirror row_mask:0xf bank_mask:0xf
v_cvt_pk_bf16_f32 v33, v33, v33
v_and_b32 v33, s60, v33
v_mul_f32 v33, s61, v33
v_cvt_pk_bf16_f32 v33, v33, v33
v_and_b32 v59, s60, v33
v_max_f32 v2, v2, v59
s_waitcnt vmcnt(6)
s_cbranch_vccnz L_fb67
s_waitcnt vmcnt(4)
L_fb67:
buffer_load_dwordx4 v[176:179], v1, s[8:11], s39 offen offset:128 nt
v_dot2_f32_bf16 v32, v148, v8, 0
v_dot2_f32_bf16 v32, v149, v9, v32
v_dot2_f32_bf16 v32, v150, v10, v32
v_dot2_f32_bf16 v32, v151, v11, v32
s_waitcnt vmcnt(6)
s_cbranch_vccnz L_fb68
s_waitcnt vmcnt(4)
L_fb68:
buffer_load_dwordx4 v[180:183], v1, s[8:11], s39 offen offset:256 nt
v_dot2_f32_bf16 v32, v152, v12, v32
v_dot2_f32_bf16 v32, v153, v13, v32
v_dot2_f32_bf16 v32, v154, v14, v32
v_dot2_f32_bf16 v32, v155, v15, v32
s_waitcnt vmcnt(6)
s_cbranch_vccnz L_fb69
s_waitcnt vmcnt(4)
L_fb69:
s_add_u32 s39, s7, 2260992
buffer_load_dwordx4 v[184:187], v1, s[8:11], s39 offen offset:0 nt
v_dot2_f32_bf16 v32, v156, v16, v32
v_dot2_f32_bf16 v32, v157, v17, v32
v_dot2_f32_bf16 v32, v158, v18, v32
v_dot2_f32_bf16 v32, v159, v19, v32
s_nop 2
v_add_f32_dpp v33, v32, v32 quad_perm:[1,0,3,2] row_mask:0xf bank_mask:0xf
s_nop 1
v_add_f32_dpp v33, v33, v33 quad_perm:[2,3,0,1] row_mask:0xf bank_mask:0xf
s_nop 1
v_add_f32_dpp v33, v33, v33 row_half_mirror row_mask:0xf bank_mask:0xf
v_cvt_pk_bf16_f32 v33, v33, v33
v_and_b32 v33, s60, v33
v_mul_f32 v33, s61, v33
v_cvt_pk_bf16_f32 v33, v33, v33
v_and_b32 v60, s60, v33
v_max_f32 v2, v2, v60
s_waitcnt vmcnt(6)
s_cbranch_vccnz L_fb70
s_waitcnt vmcnt(4)
L_fb70:
buffer_load_dwordx4 v[188:191], v1, s[8:11], s39 offen offset:128 nt
s_memrealtime s[88:89]
ds_read_b64 v[252:253], v21 offset:15904
v_dot2_f32_bf16 v32, v160, v8, 0
v_dot2_f32_bf16 v32, v161, v9, v32
v_dot2_f32_bf16 v32, v162, v10, v32
v_dot2_f32_bf16 v32, v163, v11, v32
s_waitcnt vmcnt(6)
s_cbranch_vccnz L_fb71
s_waitcnt vmcnt(4)
L_fb71:
buffer_load_dwordx4 v[192:195], v1, s[8:11], s39 offen offset:256 nt
s_waitcnt lgkmcnt(0)
v_mov_b32 v255, 1208
v_mul_u32_u24 v253, v255, v253
v_mov_b32 v254, s88
v_lshrrev_b32 v253, 12, v253
ds_write_b64 v21, v[254:255] offset:15872
v_add_u32 v253, v253, v252
v_sub_u32 v253, v254, v253
v_cmp_lt_i32 vcc, 0, v253
v_dot2_f32_bf16 v32, v164, v12, v32
v_dot2_f32_bf16 v32, v165, v13, v32
v_dot2_f32_bf16 v32, v166, v14, v32
v_dot2_f32_bf16 v32, v167, v15, v32
s_waitcnt vmcnt(6)
s_cbranch_vccnz L_fb72
s_waitcnt vmcnt(4)
L_fb72:
s_add_u32 s39, s7, 2359296
buffer_load_dwordx4 v[196:199], v1, s[8:11], s39 offen offset:0 nt
v_dot2_f32_bf16 v32, v168, v16, v32
v_dot2_f32_bf16 v32, v169, v17, v32
v_dot2_f32_bf16 v32, v170, v18, v32
v_dot2_f32_bf16 v32, v171, v19, v32
s_nop 2
v_add_f32_dpp v33, v32, v32 quad_perm:[1,0,3,2] row_mask:0xf bank_mask:0xf
s_nop 1
v_add_f32_dpp v33, v33, v33 quad_perm:[2,3,0,1] row_mask:0xf bank_mask:0xf
s_nop 1
v_add_f32_dpp v33, v33, v33 row_half_mirror row_mask:0xf bank_mask:0xf
v_cvt_pk_bf16_f32 v33, v33, v33
v_and_b32 v33, s60, v33
v_mul_f32 v33, s61, v33
v_cvt_pk_bf16_f32 v33, v33, v33
v_and_b32 v61, s60, v33
v_max_f32 v2, v2, v61
s_waitcnt vmcnt(6)
s_cbranch_vccnz L_fb73
s_waitcnt vmcnt(4)
L_fb73:
buffer_load_dwordx4 v[200:203], v1, s[8:11], s39 offen offset:128 nt
v_dot2_f32_bf16 v32, v172, v8, 0
v_dot2_f32_bf16 v32, v173, v9, v32
v_dot2_f32_bf16 v32, v174, v10, v32
v_dot2_f32_bf16 v32, v175, v11, v32
s_waitcnt vmcnt(6)
s_cbranch_vccnz L_fb74
s_waitcnt vmcnt(4)
L_fb74:
buffer_load_dwordx4 v[204:207], v1, s[8:11], s39 offen offset:256 nt
v_dot2_f32_bf16 v32, v176, v12, v32
v_dot2_f32_bf16 v32, v177, v13, v32
v_dot2_f32_bf16 v32, v178, v14, v32
v_dot2_f32_bf16 v32, v179, v15, v32
s_waitcnt vmcnt(6)
s_cbranch_vccnz L_fb75
s_waitcnt vmcnt(4)
L_fb75:
s_add_u32 s39, s7, 2457600
buffer_load_dwordx4 v[208:211], v1, s[8:11], s39 offen offset:0 nt
v_dot2_f32_bf16 v32, v180, v16, v32
v_dot2_f32_bf16 v32, v181, v17, v32
v_dot2_f32_bf16 v32, v182, v18, v32
v_dot2_f32_bf16 v32, v183, v19, v32
s_nop 2
v_add_f32_dpp v33, v32, v32 quad_perm:[1,0,3,2] row_mask:0xf bank_mask:0xf
s_nop 1
v_add_f32_dpp v33, v33, v33 quad_perm:[2,3,0,1] row_mask:0xf bank_mask:0xf
s_nop 1
v_add_f32_dpp v33, v33, v33 row_half_mirror row_mask:0xf bank_mask:0xf
v_cvt_pk_bf16_f32 v33, v33, v33
v_and_b32 v33, s60, v33
v_mul_f32 v33, s61, v33
v_cvt_pk_bf16_f32 v33, v33, v33
v_and_b32 v62, s60, v33
v_max_f32 v2, v2, v62
s_waitcnt vmcnt(6)
s_cbranch_vccnz L_fb76
s_waitcnt vmcnt(4)
L_fb76:
buffer_load_dwordx4 v[212:215], v1, s[8:11], s39 offen offset:128 nt
s_memrealtime s[88:89]
ds_read_b64 v[252:253], v21 offset:15904
v_dot2_f32_bf16 v32, v184, v8, 0
v_dot2_f32_bf16 v32, v185, v9, v32
v_dot2_f32_bf16 v32, v186, v10, v32
v_dot2_f32_bf16 v32, v187, v11, v32
s_waitcnt vmcnt(6)
s_cbranch_vccnz L_fb77
s_waitcnt vmcnt(4)
L_fb77:
buffer_load_dwordx4 v[216:219], v1, s[8:11], s39 offen offset:256 nt
s_waitcnt lgkmcnt(0)
v_mov_b32 v255, 1302
v_mul_u32_u24 v253, v255, v253
v_mov_b32 v254, s88
v_lshrrev_b32 v253, 12, v253
ds_write_b64 v21, v[254:255] offset:15872
v_add_u32 v253, v253, v252
v_sub_u32 v253, v254, v253
v_cmp_lt_i32 vcc, 0, v253
v_dot2_f32_bf16 v32, v188, v12, v32
v_dot2_f32_bf16 v32, v189, v13, v32
v_dot2_f32_bf16 v32, v190, v14, v32
v_dot2_f32_bf16 v32, v191, v15, v32
s_waitcnt vmcnt(6)
s_cbranch_vccnz L_fb78
s_waitcnt vmcnt(4)
L_fb78:
s_add_u32 s39, s7, 2555904
buffer_load_dwordx4 v[220:223], v1, s[8:11], s39 offen offset:0 nt
v_dot2_f32_bf16 v32, v192, v16, v32
v_dot2_f32_bf16 v32, v193, v17, v32
v_dot2_f32_bf16 v32, v194, v18, v32
v_dot2_f32_bf16 v32, v195, v19, v32
s_nop 2
v_add_f32_dpp v33, v32, v32 quad_perm:[1,0,3,2] row_mask:0xf bank_mask:0xf
s_nop 1
v_add_f32_dpp v33, v33, v33 quad_perm:[2,3,0,1] row_mask:0xf bank_mask:0xf
s_nop 1
v_add_f32_dpp v33, v33, v33 row_half_mirror row_mask:0xf bank_mask:0xf
v_cvt_pk_bf16_f32 v33, v33, v33
v_and_b32 v33, s60, v33
v_mul_f32 v33, s61, v33
v_cvt_pk_bf16_f32 v33, v33, v33
v_and_b32 v63, s60, v33
v_max_f32 v2, v2, v63
s_waitcnt vmcnt(6)
s_cbranch_vccnz L_fb79
s_waitcnt vmcnt(4)
L_fb79:
buffer_load_dwordx4 v[224:227], v1, s[8:11], s39 offen offset:128 nt
v_dot2_f32_bf16 v32, v196, v8, 0
v_dot2_f32_bf16 v32, v197, v9, v32
v_dot2_f32_bf16 v32, v198, v10, v32
v_dot2_f32_bf16 v32, v199, v11, v32
s_waitcnt vmcnt(6)
s_cbranch_vccnz L_fb80
s_waitcnt vmcnt(4)
L_fb80:
buffer_load_dwordx4 v[228:231], v1, s[8:11], s39 offen offset:256 nt
v_dot2_f32_bf16 v32, v200, v12, v32
v_dot2_f32_bf16 v32, v201, v13, v32
v_dot2_f32_bf16 v32, v202, v14, v32
v_dot2_f32_bf16 v32, v203, v15, v32
s_waitcnt vmcnt(6)
s_cbranch_vccnz L_fb81
s_waitcnt vmcnt(4)
L_fb81:
s_add_u32 s39, s7, 2654208
buffer_load_dwordx4 v[232:235], v1, s[8:11], s39 offen offset:0 nt
v_dot2_f32_bf16 v32, v204, v16, v32
v_dot2_f32_bf16 v32, v205, v17, v32
v_dot2_f32_bf16 v32, v206, v18, v32
v_dot2_f32_bf16 v32, v207, v19, v32
s_nop 2
v_add_f32_dpp v33, v32, v32 quad_perm:[1,0,3,2] row_mask:0xf bank_mask:0xf
s_nop 1
v_add_f32_dpp v33, v33, v33 quad_perm:[2,3,0,1] row_mask:0xf bank_mask:0xf
s_nop 1
v_add_f32_dpp v33, v33, v33 row_half_mirror row_mask:0xf bank_mask:0xf
v_cvt_pk_bf16_f32 v33, v33, v33
v_and_b32 v33, s60, v33
v_mul_f32 v33, s61, v33
v_cvt_pk_bf16_f32 v33, v33, v33
v_and_b32 v64, s60, v33
v_max_f32 v2, v2, v64
s_waitcnt vmcnt(6)
s_cbranch_vccnz L_fb82
s_waitcnt vmcnt(4)
L_fb82:
buffer_load_dwordx4 v[236:239], v1, s[8:11], s39 offen offset:128 nt
s_memrealtime s[88:89]
ds_read_b64 v[252:253], v21 offset:15904
v_dot2_f32_bf16 v32, v208, v8, 0
v_dot2_f32_bf16 v32, v209, v9, v32
v_dot2_f32_bf16 v32, v210, v10, v32
v_dot2_f32_bf16 v32, v211, v11, v32
s_waitcnt vmcnt(6)
s_cbranch_vccnz L_fb83
s_waitcnt vmcnt(4)
L_fb83:
buffer_load_dwordx4 v[240:243], v1, s[8:11], s39 offen offset:256 nt
s_waitcnt lgkmcnt(0)
v_mov_b32 v255, 1396
v_mul_u32_u24 v253, v255, v253
v_mov_b32 v254, s88
v_lshrrev_b32 v253, 12, v253
ds_write_b64 v21, v[254:255] offset:15872
v_add_u32 v253, v253, v252
v_sub_u32 v253, v254, v253
v_cmp_lt_i32 vcc, 0, v253
v_dot2_f32_bf16 v32, v212, v12, v32
v_dot2_f32_bf16 v32, v213, v13, v32
v_dot2_f32_bf16 v32, v214, v14, v32
v_dot2_f32_bf16 v32, v215, v15, v32
s_waitcnt vmcnt(6)
s_cbranch_vccnz L_fb84
s_waitcnt vmcnt(4)
L_fb84:
s_add_u32 s39, s7, 2752512
buffer_load_dwordx4 v[244:247], v1, s[8:11], s39 offen offset:0 nt
v_dot2_f32_bf16 v32, v216, v16, v32
v_dot2_f32_bf16 v32, v217, v17, v32
v_dot2_f32_bf16 v32, v218, v18, v32
v_dot2_f32_bf16 v32, v219, v19, v32
s_nop 2
v_add_f32_dpp v33, v32, v32 quad_perm:[1,0,3,2] row_mask:0xf bank_mask:0xf
s_nop 1
v_add_f32_dpp v33, v33, v33 quad_perm:[2,3,0,1] row_mask:0xf bank_mask:0xf
s_nop 1
v_add_f32_dpp v33, v33, v33 row_half_mirror row_mask:0xf bank_mask:0xf
v_cvt_pk_bf16_f32 v33, v33, v33
v_and_b32 v33, s60, v33
v_mul_f32 v33, s61, v33
v_cvt_pk_bf16_f32 v33, v33, v33
v_and_b32 v65, s60, v33
v_max_f32 v2, v2, v65
s_waitcnt vmcnt(6)
s_cbranch_vccnz L_fb85
s_waitcnt vmcnt(4)
L_fb85:
buffer_load_dwordx4 v[248:251], v1, s[8:11], s39 offen offset:128 nt
v_dot2_f32_bf16 v32, v220, v8, 0
v_dot2_f32_bf16 v32, v221, v9, v32
v_dot2_f32_bf16 v32, v222, v10, v32
v_dot2_f32_bf16 v32, v223, v11, v32
s_waitcnt vmcnt(6)
s_cbranch_vccnz L_fb86
s_waitcnt vmcnt(4)
L_fb86:
buffer_load_dwordx4 v[104:107], v1, s[8:11], s39 offen offset:256 nt
v_dot2_f32_bf16 v32, v224, v12, v32
v_dot2_f32_bf16 v32, v225, v13, v32
v_dot2_f32_bf16 v32, v226, v14, v32
v_dot2_f32_bf16 v32, v227, v15, v32
s_waitcnt vmcnt(6)
s_cbranch_vccnz L_fb87
s_waitcnt vmcnt(4)
L_fb87:
s_add_u32 s39, s7, 2850816
buffer_load_dwordx4 v[108:111], v1, s[8:11], s39 offen offset:0 nt
v_dot2_f32_bf16 v32, v228, v16, v32
v_dot2_f32_bf16 v32, v229, v17, v32
v_dot2_f32_bf16 v32, v230, v18, v32
v_dot2_f32_bf16 v32, v231, v19, v32
s_nop 2
v_add_f32_dpp v33, v32, v32 quad_perm:[1,0,3,2] row_mask:0xf bank_mask:0xf
s_nop 1
v_add_f32_dpp v33, v33, v33 quad_perm:[2,3,0,1] row_mask:0xf bank_mask:0xf
s_nop 1
v_add_f32_dpp v33, v33, v33 row_half_mirror row_mask:0xf bank_mask:0xf
v_cvt_pk_bf16_f32 v33, v33, v33
v_and_b32 v33, s60, v33
v_mul_f32 v33, s61, v33
v_cvt_pk_bf16_f32 v33, v33, v33
v_and_b32 v66, s60, v33
v_max_f32 v2, v2, v66
s_waitcnt vmcnt(6)
s_cbranch_vccnz L_fb88
s_waitcnt vmcnt(4)
L_fb88:
buffer_load_dwordx4 v[112:115], v1, s[8:11], s39 offen offset:128 nt
s_memrealtime s[88:89]
ds_read_b64 v[252:253], v21 offset:15904
v_dot2_f32_bf16 v32, v232, v8, 0
v_dot2_f32_bf16 v32, v233, v9, v32
v_dot2_f32_bf16 v32, v234, v10, v32
v_dot2_f32_bf16 v32, v235, v11, v32
s_waitcnt vmcnt(6)
s_cbranch_vccnz L_fb89
s_waitcnt vmcnt(4)
L_fb89:
buffer_load_dwordx4 v[116:119], v1, s[8:11], s39 offen offset:256 nt
s_waitcnt lgkmcnt(0)
v_mov_b32 v255, 1491
v_mul_u32_u24 v253, v255, v253
v_mov_b32 v254, s88
v_lshrrev_b32 v253, 12, v253
ds_write_b64 v21, v[254:255] offset:15872
v_add_u32 v253, v253, v252
v_sub_u32 v253, v254, v253
v_cmp_lt_i32 vcc, 0, v253
v_dot2_f32_bf16 v32, v236, v12, v32
v_dot2_f32_bf16 v32, v237, v13, v32
v_dot2_f32_bf16 v32, v238, v14, v32
v_dot2_f32_bf16 v32, v239, v15, v32
s_waitcnt vmcnt(6)
s_cbranch_vccnz L_fb90
s_waitcnt vmcnt(4)
L_fb90:
s_add_u32 s39, s7, 2949120
buffer_load_dwordx4 v[120:123], v1, s[8:11], s39 offen offset:0 nt
v_dot2_f32_bf16 v32, v240, v16, v32
v_dot2_f32_bf16 v32, v241, v17, v32
v_dot2_f32_bf16 v32, v242, v18, v32
v_dot2_f32_bf16 v32, v243, v19, v32
s_nop 2
v_add_f32_dpp v33, v32, v32 quad_perm:[1,0,3,2] row_mask:0xf bank_mask:0xf
s_nop 1
v_add_f32_dpp v33, v33, v33 quad_perm:[2,3,0,1] row_mask:0xf bank_mask:0xf
s_nop 1
v_add_f32_dpp v33, v33, v33 row_half_mirror row_mask:0xf bank_mask:0xf
v_cvt_pk_bf16_f32 v33, v33, v33
v_and_b32 v33, s60, v33
v_mul_f32 v33, s61, v33
v_cvt_pk_bf16_f32 v33, v33, v33
v_and_b32 v67, s60, v33
v_max_f32 v2, v2, v67
s_waitcnt vmcnt(6)
s_cbranch_vccnz L_fb91
s_waitcnt vmcnt(4)
L_fb91:
buffer_load_dwordx4 v[124:127], v1, s[8:11], s39 offen offset:128 nt
v_dot2_f32_bf16 v32, v244, v8, 0
v_dot2_f32_bf16 v32, v245, v9, v32
v_dot2_f32_bf16 v32, v246, v10, v32
v_dot2_f32_bf16 v32, v247, v11, v32
s_waitcnt vmcnt(6)
s_cbranch_vccnz L_fb92
s_waitcnt vmcnt(4)
L_fb92:
buffer_load_dwordx4 v[128:131], v1, s[8:11], s39 offen offset:256 nt
v_dot2_f32_bf16 v32, v248, v12, v32
v_dot2_f32_bf16 v32, v249, v13, v32
v_dot2_f32_bf16 v32, v250, v14, v32
v_dot2_f32_bf16 v32, v251, v15, v32
s_waitcnt vmcnt(6)
s_cbranch_vccnz L_fb93
s_waitcnt vmcnt(4)
L_fb93:
s_add_u32 s39, s7, 3047424
buffer_load_dwordx4 v[132:135], v1, s[8:11], s39 offen offset:0 nt
v_dot2_f32_bf16 v32, v104, v16, v32
v_dot2_f32_bf16 v32, v105, v17, v32
v_dot2_f32_bf16 v32, v106, v18, v32
v_dot2_f32_bf16 v32, v107, v19, v32
s_nop 2
v_add_f32_dpp v33, v32, v32 quad_perm:[1,0,3,2] row_mask:0xf bank_mask:0xf
s_nop 1
v_add_f32_dpp v33, v33, v33 quad_perm:[2,3,0,1] row_mask:0xf bank_mask:0xf
s_nop 1
v_add_f32_dpp v33, v33, v33 row_half_mirror row_mask:0xf bank_mask:0xf
v_cvt_pk_bf16_f32 v33, v33, v33
v_and_b32 v33, s60, v33
v_mul_f32 v33, s61, v33
v_cvt_pk_bf16_f32 v33, v33, v33
v_and_b32 v68, s60, v33
v_max_f32 v2, v2, v68
s_waitcnt vmcnt(6)
s_cbranch_vccnz L_fb94
s_waitcnt vmcnt(4)
L_fb94:
buffer_load_dwordx4 v[136:139], v1, s[8:11], s39 offen offset:128 nt
s_memrealtime s[88:89]
ds_read_b64 v[252:253], v21 offset:15904
v_dot2_f32_bf16 v32, v108, v8, 0
v_dot2_f32_bf16 v32, v109, v9, v32
v_dot2_f32_bf16 v32, v110, v10, v32
v_dot2_f32_bf16 v32, v111, v11, v32
s_waitcnt vmcnt(6)
s_cbranch_vccnz L_fb95
s_waitcnt vmcnt(4)
L_fb95:
buffer_load_dwordx4 v[140:143], v1, s[8:11], s39 offen offset:256 nt
s_waitcnt lgkmcnt(0)
v_mov_b32 v255, 1574
v_mul_u32_u24 v253, v255, v253
v_mov_b32 v254, s88
v_lshrrev_b32 v253, 12, v253
ds_write_b64 v21, v[254:255] offset:15872
v_add_u32 v253, v253, v252
v_sub_u32 v253, v254, v253
v_cmp_lt_i32 vcc, 0, v253
v_dot2_f32_bf16 v32, v112, v12, v32
v_dot2_f32_bf16 v32, v113, v13, v32
v_dot2_f32_bf16 v32, v114, v14, v32
v_dot2_f32_bf16 v32, v115, v15, v32
s_waitcnt vmcnt(6)
s_cbranch_vccnz L_fb96
s_waitcnt vmcnt(4)
L_fb96:
s_add_u32 s39, s7, 3145728
buffer_load_dwordx4 v[144:147], v1, s[8:11], s39 offen offset:0 nt
v_dot2_f32_bf16 v32, v116, v16, v32
v_dot2_f32_bf16 v32, v117, v17, v32
v_dot2_f32_bf16 v32, v118, v18, v32
v_dot2_f32_bf16 v32, v119, v19, v32
s_nop 2
v_add_f32_dpp v33, v32, v32 quad_perm:[1,0,3,2] row_mask:0xf bank_mask:0xf
s_nop 1
v_add_f32_dpp v33, v33, v33 quad_perm:[2,3,0,1] row_mask:0xf bank_mask:0xf
s_nop 1
v_add_f32_dpp v33, v33, v33 row_half_mirror row_mask:0xf bank_mask:0xf
v_cvt_pk_bf16_f32 v33, v33, v33
v_and_b32 v33, s60, v33
v_mul_f32 v33, s61, v33
v_cvt_pk_bf16_f32 v33, v33, v33
v_and_b32 v69, s60, v33
v_max_f32 v2, v2, v69
s_waitcnt vmcnt(6)
s_cbranch_vccnz L_fb97
s_waitcnt vmcnt(4)
L_fb97:
buffer_load_dwordx4 v[148:151], v1, s[8:11], s39 offen offset:128 nt
v_dot2_f32_bf16 v32, v120, v8, 0
v_dot2_f32_bf16 v32, v121, v9, v32
v_dot2_f32_bf16 v32, v122, v10, v32
v_dot2_f32_bf16 v32, v123, v11, v32
s_waitcnt vmcnt(6)
s_cbranch_vccnz L_fb98
s_waitcnt vmcnt(4)
L_fb98:
buffer_load_dwordx4 v[152:155], v1, s[8:11], s39 offen offset:256 nt
v_dot2_f32_bf16 v32, v124, v12, v32
v_dot2_f32_bf16 v32, v125, v13, v32
v_dot2_f32_bf16 v32, v126, v14, v32
v_dot2_f32_bf16 v32, v127, v15, v32
s_waitcnt vmcnt(6)
s_cbranch_vccnz L_fb99
s_waitcnt vmcnt(4)
L_fb99:
s_add_u32 s39, s7, 3244032
buffer_load_dwordx4 v[156:159], v1, s[8:11], s39 offen offset:0 nt
v_dot2_f32_bf16 v32, v128, v16, v32
v_dot2_f32_bf16 v32, v129, v17, v32
v_dot2_f32_bf16 v32, v130, v18, v32
v_dot2_f32_bf16 v32, v131, v19, v32
s_nop 2
v_add_f32_dpp v33, v32, v32 quad_perm:[1,0,3,2] row_mask:0xf bank_mask:0xf
s_nop 1
v_add_f32_dpp v33, v33, v33 quad_perm:[2,3,0,1] row_mask:0xf bank_mask:0xf
s_nop 1
v_add_f32_dpp v33, v33, v33 row_half_mirror row_mask:0xf bank_mask:0xf
v_cvt_pk_bf16_f32 v33, v33, v33
v_and_b32 v33, s60, v33
v_mul_f32 v33, s61, v33
v_cvt_pk_bf16_f32 v33, v33, v33
v_and_b32 v70, s60, v33
v_max_f32 v2, v2, v70
s_waitcnt vmcnt(6)
s_cbranch_vccnz L_fb100
s_waitcnt vmcnt(4)
L_fb100:
buffer_load_dwordx4 v[160:163], v1, s[8:11], s39 offen offset:128 nt
s_memrealtime s[88:89]
ds_read_b64 v[252:253], v21 offset:15904
v_dot2_f32_bf16 v32, v132, v8, 0
v_dot2_f32_bf16 v32, v133, v9, v32
v_dot2_f32_bf16 v32, v134, v10, v32
v_dot2_f32_bf16 v32, v135, v11, v32
s_waitcnt vmcnt(6)
s_cbranch_vccnz L_fb101
s_waitcnt vmcnt(4)
L_fb101:
buffer_load_dwordx4 v[164:167], v1, s[8:11], s39 offen offset:256 nt
s_waitcnt lgkmcnt(0)
v_mov_b32 v255, 1655
v_mul_u32_u24 v253, v255, v253
v_mov_b32 v254, s88
v_lshrrev_b32 v253, 12, v253
ds_write_b64 v21, v[254:255] offset:15872
v_add_u32 v253, v253, v252
v_sub_u32 v253, v254, v253
v_cmp_lt_i32 vcc, 0, v253
v_dot2_f32_bf16 v32, v136, v12, v32
v_dot2_f32_bf16 v32, v137, v13, v32
v_dot2_f32_bf16 v32, v138, v14, v32
v_dot2_f32_bf16 v32, v139, v15, v32
s_waitcnt vmcnt(6)
s_cbranch_vccnz L_fb102
s_waitcnt vmcnt(4)
L_fb102:
s_add_u32 s39, s7, 3342336
buffer_load_dwordx4 v[168:171], v1, s[8:11], s39 offen offset:0 nt
v_dot2_f32_bf16 v32, v140, v16, v32
v_dot2_f32_bf16 v32, v141, v17, v32
v_dot2_f32_bf16 v32, v142, v18, v32
v_dot2_f32_bf16 v32, v143, v19, v32
s_nop 2
v_add_f32_dpp v33, v32, v32 quad_perm:[1,0,3,2] row_mask:0xf bank_mask:0xf
s_nop 1
v_add_f32_dpp v33, v33, v33 quad_perm:[2,3,0,1] row_mask:0xf bank_mask:0xf
s_nop 1
v_add_f32_dpp v33, v33, v33 row_half_mirror row_mask:0xf bank_mask:0xf
v_cvt_pk_bf16_f32 v33, v33, v33
v_and_b32 v33, s60, v33
v_mul_f32 v33, s61, v33
v_cvt_pk_bf16_f32 v33, v33, v33
v_and_b32 v71, s60, v33
v_max_f32 v2, v2, v71
s_waitcnt vmcnt(6)
s_cbranch_vccnz L_fb103
s_waitcnt vmcnt(4)
L_fb103:
buffer_load_dwordx4 v[172:175], v1, s[8:11], s39 offen offset:128 nt
v_dot2_f32_bf16 v32, v144, v8, 0
v_dot2_f32_bf16 v32, v145, v9, v32
v_dot2_f32_bf16 v32, v146, v10, v32
v_dot2_f32_bf16 v32, v147, v11, v32
s_waitcnt vmcnt(6)
s_cbranch_vccnz L_fb104
s_waitcnt vmcnt(4)
L_fb104:
buffer_load_dwordx4 v[176:179], v1, s[8:11], s39 offen offset:256 nt
v_dot2_f32_bf16 v32, v148, v12, v32
v_dot2_f32_bf16 v32, v149, v13, v32
v_dot2_f32_bf16 v32, v150, v14, v32
v_dot2_f32_bf16 v32, v151, v15, v32
s_waitcnt vmcnt(6)
s_cbranch_vccnz L_fb105
s_waitcnt vmcnt(4)
L_fb105:
s_add_u32 s39, s7, 3440640
buffer_load_dwordx4 v[180:183], v1, s[8:11], s39 offen offset:0 nt
v_dot2_f32_bf16 v32, v152, v16, v32
v_dot2_f32_bf16 v32, v153, v17, v32
v_dot2_f32_bf16 v32, v154, v18, v32
v_dot2_f32_bf16 v32, v155, v19, v32
s_nop 2
v_add_f32_dpp v33, v32, v32 quad_perm:[1,0,3,2] row_mask:0xf bank_mask:0xf
s_nop 1
v_add_f32_dpp v33, v33, v33 quad_perm:[2,3,0,1] row_mask:0xf bank_mask:0xf
s_nop 1
v_add_f32_dpp v33, v33, v33 row_half_mirror row_mask:0xf bank_mask:0xf
v_cvt_pk_bf16_f32 v33, v33, v33
v_and_b32 v33, s60, v33
v_mul_f32 v33, s61, v33
v_cvt_pk_bf16_f32 v33, v33, v33
v_and_b32 v72, s60, v33
v_max_f32 v2, v2, v72
s_waitcnt vmcnt(6)
s_cbranch_vccnz L_fb106
s_waitcnt vmcnt(4)
L_fb106:
buffer_load_dwordx4 v[184:187], v1, s[8:11], s39 offen offset:128 nt
s_memrealtime s[88:89]
ds_read_b64 v[252:253], v21 offset:15904
v_dot2_f32_bf16 v32, v156, v8, 0
v_dot2_f32_bf16 v32, v157, v9, v32
v_dot2_f32_bf16 v32, v158, v10, v32
v_dot2_f32_bf16 v32, v159, v11, v32
s_waitcnt vmcnt(6)
s_cbranch_vccnz L_fb107
s_waitcnt vmcnt(4)
L_fb107:
buffer_load_dwordx4 v[188:191], v1, s[8:11], s39 offen offset:256 nt
s_waitcnt lgkmcnt(0)
v_mov_b32 v255, 1736
v_mul_u32_u24 v253, v255, v253
v_mov_b32 v254, s88
v_lshrrev_b32 v253, 12, v253
ds_write_b64 v21, v[254:255] offset:15872
v_add_u32 v253, v253, v252
v_sub_u32 v253, v254, v253
v_cmp_lt_i32 vcc, 0, v253
v_dot2_f32_bf16 v32, v160, v12, v32
v_dot2_f32_bf16 v32, v161, v13, v32
v_dot2_f32_bf16 v32, v162, v14, v32
v_dot2_f32_bf16 v32, v163, v15, v32
s_waitcnt vmcnt(6)
s_cbranch_vccnz L_fb108
s_waitcnt vmcnt(4)
L_fb108:
s_add_u32 s39, s7, 3538944
buffer_load_dwordx4 v[192:195], v1, s[8:11], s39 offen offset:0 nt
v_dot2_f32_bf16 v32, v164, v16, v32
v_dot2_f32_bf16 v32, v165, v17, v32
v_dot2_f32_bf16 v32, v166, v18, v32
v_dot2_f32_bf16 v32, v167, v19, v32
s_nop 2
v_add_f32_dpp v33, v32, v32 quad_perm:[1,0,3,2] row_mask:0xf bank_mask:0xf
s_nop 1
v_add_f32_dpp v33, v33, v33 quad_perm:[2,3,0,1] row_mask:0xf bank_mask:0xf
s_nop 1
v_add_f32_dpp v33, v33, v33 row_half_mirror row_mask:0xf bank_mask:0xf
v_cvt_pk_bf16_f32 v33, v33, v33
v_and_b32 v33, s60, v33
v_mul_f32 v33, s61, v33
v_cvt_pk_bf16_f32 v33, v33, v33
v_and_b32 v73, s60, v33
v_max_f32 v2, v2, v73
s_waitcnt vmcnt(6)
s_cbranch_vccnz L_fb109
s_waitcnt vmcnt(4)
L_fb109:
buffer_load_dwordx4 v[196:199], v1, s[8:11], s39 offen offset:128 nt
v_dot2_f32_bf16 v32, v168, v8, 0
v_dot2_f32_bf16 v32, v169, v9, v32
v_dot2_f32_bf16 v32, v170, v10, v32
v_dot2_f32_bf16 v32, v171, v11, v32
s_waitcnt vmcnt(6)
s_cbranch_vccnz L_fb110
s_waitcnt vmcnt(4)
L_fb110:
buffer_load_dwordx4 v[200:203], v1, s[8:11], s39 offen offset:256 nt
v_dot2_f32_bf16 v32, v172, v12, v32
v_dot2_f32_bf16 v32, v173, v13, v32
v_dot2_f32_bf16 v32, v174, v14, v32
v_dot2_f32_bf16 v32, v175, v15, v32
s_waitcnt vmcnt(6)
s_cbranch_vccnz L_fb111
s_waitcnt vmcnt(4)
L_fb111:
s_add_u32 s39, s7, 3637248
buffer_load_dwordx4 v[204:207], v1, s[8:11], s39 offen offset:0 nt
v_dot2_f32_bf16 v32, v176, v16, v32
v_dot2_f32_bf16 v32, v177, v17, v32
v_dot2_f32_bf16 v32, v178, v18, v32
v_dot2_f32_bf16 v32, v179, v19, v32
s_nop 2
v_add_f32_dpp v33, v32, v32 quad_perm:[1,0,3,2] row_mask:0xf bank_mask:0xf
s_nop 1
v_add_f32_dpp v33, v33, v33 quad_perm:[2,3,0,1] row_mask:0xf bank_mask:0xf
s_nop 1
v_add_f32_dpp v33, v33, v33 row_half_mirror row_mask:0xf bank_mask:0xf
v_cvt_pk_bf16_f32 v33, v33, v33
v_and_b32 v33, s60, v33
v_mul_f32 v33, s61, v33
v_cvt_pk_bf16_f32 v33, v33, v33
v_and_b32 v74, s60, v33
v_max_f32 v2, v2, v74
s_waitcnt vmcnt(6)
s_cbranch_vccnz L_fb112
s_waitcnt vmcnt(4)
L_fb112:
buffer_load_dwordx4 v[208:211], v1, s[8:11], s39 offen offset:128 nt
s_memrealtime s[88:89]
ds_read_b64 v[252:253], v21 offset:15904
v_dot2_f32_bf16 v32, v180, v8, 0
v_dot2_f32_bf16 v32, v181, v9, v32
v_dot2_f32_bf16 v32, v182, v10, v32
v_dot2_f32_bf16 v32, v183, v11, v32
s_waitcnt vmcnt(6)
s_cbranch_vccnz L_fb113
s_waitcnt vmcnt(4)
L_fb113:
buffer_load_dwordx4 v[212:215], v1, s[8:11], s39 offen offset:256 nt
s_waitcnt lgkmcnt(0)
v_mov_b32 v255, 1817
v_mul_u32_u24 v253, v255, v253
v_mov_b32 v254, s88
v_lshrrev_b32 v253, 12, v253
ds_write_b64 v21, v[254:255] offset:15872
v_add_u32 v253, v253, v252
v_sub_u32 v253, v254, v253
v_cmp_lt_i32 vcc, 0, v253
v_dot2_f32_bf16 v32, v184, v12, v32
v_dot2_f32_bf16 v32, v185, v13, v32
v_dot2_f32_bf16 v32, v186, v14, v32
v_dot2_f32_bf16 v32, v187, v15, v32
s_waitcnt vmcnt(6)
s_cbranch_vccnz L_fb114
s_waitcnt vmcnt(4)
L_fb114:
s_add_u32 s39, s7, 3735552
buffer_load_dwordx4 v[216:219], v1, s[8:11], s39 offen offset:0 nt
v_dot2_f32_bf16 v32, v188, v16, v32
v_dot2_f32_bf16 v32, v189, v17, v32
v_dot2_f32_bf16 v32, v190, v18, v32
v_dot2_f32_bf16 v32, v191, v19, v32
s_nop 2
v_add_f32_dpp v33, v32, v32 quad_perm:[1,0,3,2] row_mask:0xf bank_mask:0xf
s_nop 1
v_add_f32_dpp v33, v33, v33 quad_perm:[2,3,0,1] row_mask:0xf bank_mask:0xf
s_nop 1
v_add_f32_dpp v33, v33, v33 row_half_mirror row_mask:0xf bank_mask:0xf
v_cvt_pk_bf16_f32 v33, v33, v33
v_and_b32 v33, s60, v33
v_mul_f32 v33, s61, v33
v_cvt_pk_bf16_f32 v33, v33, v33
v_and_b32 v75, s60, v33
v_max_f32 v2, v2, v75
s_waitcnt vmcnt(6)
s_cbranch_vccnz L_fb115
s_waitcnt vmcnt(4)
L_fb115:
buffer_load_dwordx4 v[220:223], v1, s[8:11], s39 offen offset:128 nt
v_dot2_f32_bf16 v32, v192, v8, 0
v_dot2_f32_bf16 v32, v193, v9, v32
v_dot2_f32_bf16 v32, v194, v10, v32
v_dot2_f32_bf16 v32, v195, v11, v32
s_waitcnt vmcnt(6)
s_cbranch_vccnz L_fb116
s_waitcnt vmcnt(4)
L_fb116:
buffer_load_dwordx4 v[224:227], v1, s[8:11], s39 offen offset:256 nt
v_dot2_f32_bf16 v32, v196, v12, v32
v_dot2_f32_bf16 v32, v197, v13, v32
v_dot2_f32_bf16 v32, v198, v14, v32
v_dot2_f32_bf16 v32, v199, v15, v32
s_waitcnt vmcnt(6)
s_cbranch_vccnz L_fb117
s_waitcnt vmcnt(4)
L_fb117:
s_add_u32 s39, s7, 3833856
buffer_load_dwordx4 v[228:231], v1, s[8:11], s39 offen offset:0 nt
v_dot2_f32_bf16 v32, v200, v16, v32
v_dot2_f32_bf16 v32, v201, v17, v32
v_dot2_f32_bf16 v32, v202, v18, v32
v_dot2_f32_bf16 v32, v203, v19, v32
s_nop 2
v_add_f32_dpp v33, v32, v32 quad_perm:[1,0,3,2] row_mask:0xf bank_mask:0xf
s_nop 1
v_add_f32_dpp v33, v33, v33 quad_perm:[2,3,0,1] row_mask:0xf bank_mask:0xf
s_nop 1
v_add_f32_dpp v33, v33, v33 row_half_mirror row_mask:0xf bank_mask:0xf
v_cvt_pk_bf16_f32 v33, v33, v33
v_and_b32 v33, s60, v33
v_mul_f32 v33, s61, v33
v_cvt_pk_bf16_f32 v33, v33, v33
v_and_b32 v76, s60, v33
v_max_f32 v2, v2, v76
s_waitcnt vmcnt(6)
s_cbranch_vccnz L_fb118
s_waitcnt vmcnt(4)
L_fb118:
buffer_load_dwordx4 v[232:235], v1, s[8:11], s39 offen offset:128 nt
s_memrealtime s[88:89]
ds_read_b64 v[252:253], v21 offset:15904
v_dot2_f32_bf16 v32, v204, v8, 0
v_dot2_f32_bf16 v32, v205, v9, v32
v_dot2_f32_bf16 v32, v206, v10, v32
v_dot2_f32_bf16 v32, v207, v11, v32
s_waitcnt vmcnt(6)
s_cbranch_vccnz L_fb119
s_waitcnt vmcnt(4)
L_fb119:
buffer_load_dwordx4 v[236:239], v1, s[8:11], s39 offen offset:256 nt
s_waitcnt lgkmcnt(0)
v_mov_b32 v255, 1898
v_mul_u32_u24 v253, v255, v253
v_mov_b32 v254, s88
v_lshrrev_b32 v253, 12, v253
ds_write_b64 v21, v[254:255] offset:15872
v_add_u32 v253, v253, v252
v_sub_u32 v253, v254, v253
v_cmp_lt_i32 vcc, 0, v253
v_dot2_f32_bf16 v32, v208, v12, v32
v_dot2_f32_bf16 v32, v209, v13, v32
v_dot2_f32_bf16 v32, v210, v14, v32
v_dot2_f32_bf16 v32, v211, v15, v32
s_waitcnt vmcnt(6)
s_cbranch_vccnz L_fb120
s_waitcnt vmcnt(4)
L_fb120:
s_add_u32 s39, s7, 3932160
buffer_load_dwordx4 v[240:243], v1, s[8:11], s39 offen offset:0 nt
v_dot2_f32_bf16 v32, v212, v16, v32
v_dot2_f32_bf16 v32, v213, v17, v32
v_dot2_f32_bf16 v32, v214, v18, v32
v_dot2_f32_bf16 v32, v215, v19, v32
s_nop 2
v_add_f32_dpp v33, v32, v32 quad_perm:[1,0,3,2] row_mask:0xf bank_mask:0xf
s_nop 1
v_add_f32_dpp v33, v33, v33 quad_perm:[2,3,0,1] row_mask:0xf bank_mask:0xf
s_nop 1
v_add_f32_dpp v33, v33, v33 row_half_mirror row_mask:0xf bank_mask:0xf
v_cvt_pk_bf16_f32 v33, v33, v33
v_and_b32 v33, s60, v33
v_mul_f32 v33, s61, v33
v_cvt_pk_bf16_f32 v33, v33, v33
v_and_b32 v77, s60, v33
v_max_f32 v2, v2, v77
s_waitcnt vmcnt(6)
s_cbranch_vccnz L_fb121
s_waitcnt vmcnt(4)
L_fb121:
buffer_load_dwordx4 v[244:247], v1, s[8:11], s39 offen offset:128 nt
v_dot2_f32_bf16 v32, v216, v8, 0
v_dot2_f32_bf16 v32, v217, v9, v32
v_dot2_f32_bf16 v32, v218, v10, v32
v_dot2_f32_bf16 v32, v219, v11, v32
s_waitcnt vmcnt(6)
s_cbranch_vccnz L_fb122
s_waitcnt vmcnt(4)
L_fb122:
buffer_load_dwordx4 v[248:251], v1, s[8:11], s39 offen offset:256 nt
v_dot2_f32_bf16 v32, v220, v12, v32
v_dot2_f32_bf16 v32, v221, v13, v32
v_dot2_f32_bf16 v32, v222, v14, v32
v_dot2_f32_bf16 v32, v223, v15, v32
s_waitcnt vmcnt(6)
s_cbranch_vccnz L_fb123
s_waitcnt vmcnt(4)
L_fb123:
s_add_u32 s39, s7, 4030464
buffer_load_dwordx4 v[104:107], v1, s[8:11], s39 offen offset:0 nt
v_dot2_f32_bf16 v32, v224, v16, v32
v_dot2_f32_bf16 v32, v225, v17, v32
v_dot2_f32_bf16 v32, v226, v18, v32
v_dot2_f32_bf16 v32, v227, v19, v32
s_nop 2
v_add_f32_dpp v33, v32, v32 quad_perm:[1,0,3,2] row_mask:0xf bank_mask:0xf
s_nop 1
v_add_f32_dpp v33, v33, v33 quad_perm:[2,3,0,1] row_mask:0xf bank_mask:0xf
s_nop 1
v_add_f32_dpp v33, v33, v33 row_half_mirror row_mask:0xf bank_mask:0xf
v_cvt_pk_bf16_f32 v33, v33, v33
v_and_b32 v33, s60, v33
v_mul_f32 v33, s61, v33
v_cvt_pk_bf16_f32 v33, v33, v33
v_and_b32 v78, s60, v33
v_max_f32 v2, v2, v78
s_waitcnt vmcnt(6)
s_cbranch_vccnz L_fb124
s_waitcnt vmcnt(4)
L_fb124:
buffer_load_dwordx4 v[108:111], v1, s[8:11], s39 offen offset:128 nt
s_memrealtime s[88:89]
ds_read_b64 v[252:253], v21 offset:15904
v_dot2_f32_bf16 v32, v228, v8, 0
v_dot2_f32_bf16 v32, v229, v9, v32
v_dot2_f32_bf16 v32, v230, v10, v32
v_dot2_f32_bf16 v32, v231, v11, v32
s_waitcnt vmcnt(6)
s_cbranch_vccnz L_fb125
s_waitcnt vmcnt(4)
L_fb125:
buffer_load_dwordx4 v[112:115], v1, s[8:11], s39 offen offset:256 nt
s_waitcnt lgkmcnt(0)
v_mov_b32 v255, 1979
v_mul_u32_u24 v253, v255, v253
v_mov_b32 v254, s88
v_lshrrev_b32 v253, 12, v253
ds_write_b64 v21, v[254:255] offset:15872
v_add_u32 v253, v253, v252
v_sub_u32 v253, v254, v253
v_cmp_lt_i32 vcc, 0, v253
v_dot2_f32_bf16 v32, v232, v12, v32
v_dot2_f32_bf16 v32, v233, v13, v32
v_dot2_f32_bf16 v32, v234, v14, v32
v_dot2_f32_bf16 v32, v235, v15, v32
s_waitcnt vmcnt(6)
s_cbranch_vccnz L_fb126
s_waitcnt vmcnt(4)
L_fb126:
s_add_u32 s39, s7, 4128768
buffer_load_dwordx4 v[116:119], v1, s[8:11], s39 offen offset:0 nt
v_dot2_f32_bf16 v32, v236, v16, v32
v_dot2_f32_bf16 v32, v237, v17, v32
v_dot2_f32_bf16 v32, v238, v18, v32
v_dot2_f32_bf16 v32, v239, v19, v32
s_nop 2
v_add_f32_dpp v33, v32, v32 quad_perm:[1,0,3,2] row_mask:0xf bank_mask:0xf
s_nop 1
v_add_f32_dpp v33, v33, v33 quad_perm:[2,3,0,1] row_mask:0xf bank_mask:0xf
s_nop 1
v_add_f32_dpp v33, v33, v33 row_half_mirror row_mask:0xf bank_mask:0xf
v_cvt_pk_bf16_f32 v33, v33, v33
v_and_b32 v33, s60, v33
v_mul_f32 v33, s61, v33
v_cvt_pk_bf16_f32 v33, v33, v33
v_and_b32 v79, s60, v33
v_max_f32 v2, v2, v79
s_waitcnt vmcnt(6)
s_cbranch_vccnz L_fb127
s_waitcnt vmcnt(4)
L_fb127:
buffer_load_dwordx4 v[120:123], v1, s[8:11], s39 offen offset:128 nt
v_dot2_f32_bf16 v32, v240, v8, 0
v_dot2_f32_bf16 v32, v241, v9, v32
v_dot2_f32_bf16 v32, v242, v10, v32
v_dot2_f32_bf16 v32, v243, v11, v32
s_waitcnt vmcnt(6)
s_cbranch_vccnz L_fb128
s_waitcnt vmcnt(4)
L_fb128:
buffer_load_dwordx4 v[124:127], v1, s[8:11], s39 offen offset:256 nt
v_dot2_f32_bf16 v32, v244, v12, v32
v_dot2_f32_bf16 v32, v245, v13, v32
v_dot2_f32_bf16 v32, v246, v14, v32
v_dot2_f32_bf16 v32, v247, v15, v32
s_waitcnt vmcnt(6)
s_cbranch_vccnz L_fb129
s_waitcnt vmcnt(4)
L_fb129:
s_add_u32 s39, s7, 4227072
buffer_load_dwordx4 v[128:131], v1, s[8:11], s39 offen offset:0 nt
v_dot2_f32_bf16 v32, v248, v16, v32
v_dot2_f32_bf16 v32, v249, v17, v32
v_dot2_f32_bf16 v32, v250, v18, v32
v_dot2_f32_bf16 v32, v251, v19, v32
s_nop 2
v_add_f32_dpp v33, v32, v32 quad_perm:[1,0,3,2] row_mask:0xf bank_mask:0xf
s_nop 1
v_add_f32_dpp v33, v33, v33 quad_perm:[2,3,0,1] row_mask:0xf bank_mask:0xf
s_nop 1
v_add_f32_dpp v33, v33, v33 row_half_mirror row_mask:0xf bank_mask:0xf
v_cvt_pk_bf16_f32 v33, v33, v33
v_and_b32 v33, s60, v33
v_mul_f32 v33, s61, v33
v_cvt_pk_bf16_f32 v33, v33, v33
v_and_b32 v80, s60, v33
v_max_f32 v2, v2, v80
s_waitcnt vmcnt(6)
s_cbranch_vccnz L_fb130
s_waitcnt vmcnt(4)
L_fb130:
buffer_load_dwordx4 v[132:135], v1, s[8:11], s39 offen offset:128 nt
s_memrealtime s[88:89]
ds_read_b64 v[252:253], v21 offset:15904
v_dot2_f32_bf16 v32, v104, v8, 0
v_dot2_f32_bf16 v32, v105, v9, v32
v_dot2_f32_bf16 v32, v106, v10, v32
v_dot2_f32_bf16 v32, v107, v11, v32
s_waitcnt vmcnt(6)
s_cbranch_vccnz L_fb131
s_waitcnt vmcnt(4)
L_fb131:
buffer_load_dwordx4 v[136:139], v1, s[8:11], s39 offen offset:256 nt
s_waitcnt lgkmcnt(0)
v_mov_b32 v255, 2060
v_mul_u32_u24 v253, v255, v253
v_mov_b32 v254, s88
v_lshrrev_b32 v253, 12, v253
ds_write_b64 v21, v[254:255] offset:15872
v_add_u32 v253, v253, v252
v_sub_u32 v253, v254, v253
v_cmp_lt_i32 vcc, 0, v253
v_dot2_f32_bf16 v32, v108, v12, v32
v_dot2_f32_bf16 v32, v109, v13, v32
v_dot2_f32_bf16 v32, v110, v14, v32
v_dot2_f32_bf16 v32, v111, v15, v32
s_waitcnt vmcnt(6)
s_cbranch_vccnz L_fb132
s_waitcnt vmcnt(4)
L_fb132:
s_add_u32 s39, s7, 4325376
buffer_load_dwordx4 v[140:143], v1, s[8:11], s39 offen offset:0 nt
v_dot2_f32_bf16 v32, v112, v16, v32
v_dot2_f32_bf16 v32, v113, v17, v32
v_dot2_f32_bf16 v32, v114, v18, v32
v_dot2_f32_bf16 v32, v115, v19, v32
s_nop 2
v_add_f32_dpp v33, v32, v32 quad_perm:[1,0,3,2] row_mask:0xf bank_mask:0xf
s_nop 1
v_add_f32_dpp v33, v33, v33 quad_perm:[2,3,0,1] row_mask:0xf bank_mask:0xf
s_nop 1
v_add_f32_dpp v33, v33, v33 row_half_mirror row_mask:0xf bank_mask:0xf
v_cvt_pk_bf16_f32 v33, v33, v33
v_and_b32 v33, s60, v33
v_mul_f32 v33, s61, v33
v_cvt_pk_bf16_f32 v33, v33, v33
v_and_b32 v81, s60, v33
v_max_f32 v2, v2, v81
s_waitcnt vmcnt(6)
s_cbranch_vccnz L_fb133
s_waitcnt vmcnt(4)
L_fb133:
buffer_load_dwordx4 v[144:147], v1, s[8:11], s39 offen offset:128 nt
v_dot2_f32_bf16 v32, v116, v8, 0
v_dot2_f32_bf16 v32, v117, v9, v32
v_dot2_f32_bf16 v32, v118, v10, v32
v_dot2_f32_bf16 v32, v119, v11, v32
s_waitcnt vmcnt(6)
s_cbranch_vccnz L_fb134
s_waitcnt vmcnt(4)
L_fb134:
buffer_load_dwordx4 v[148:151], v1, s[8:11], s39 offen offset:256 nt
v_dot2_f32_bf16 v32, v120, v12, v32
v_dot2_f32_bf16 v32, v121, v13, v32
v_dot2_f32_bf16 v32, v122, v14, v32
v_dot2_f32_bf16 v32, v123, v15, v32
s_waitcnt vmcnt(6)
s_cbranch_vccnz L_fb135
s_waitcnt vmcnt(4)
L_fb135:
s_add_u32 s39, s7, 4423680
buffer_load_dwordx4 v[152:155], v1, s[8:11], s39 offen offset:0 nt
v_dot2_f32_bf16 v32, v124, v16, v32
v_dot2_f32_bf16 v32, v125, v17, v32
v_dot2_f32_bf16 v32, v126, v18, v32
v_dot2_f32_bf16 v32, v127, v19, v32
s_nop 2
v_add_f32_dpp v33, v32, v32 quad_perm:[1,0,3,2] row_mask:0xf bank_mask:0xf
s_nop 1
v_add_f32_dpp v33, v33, v33 quad_perm:[2,3,0,1] row_mask:0xf bank_mask:0xf
s_nop 1
v_add_f32_dpp v33, v33, v33 row_half_mirror row_mask:0xf bank_mask:0xf
v_cvt_pk_bf16_f32 v33, v33, v33
v_and_b32 v33, s60, v33
v_mul_f32 v33, s61, v33
v_cvt_pk_bf16_f32 v33, v33, v33
v_and_b32 v82, s60, v33
v_max_f32 v2, v2, v82
s_waitcnt vmcnt(6)
s_cbranch_vccnz L_fb136
s_waitcnt vmcnt(4)
L_fb136:
buffer_load_dwordx4 v[156:159], v1, s[8:11], s39 offen offset:128 nt
s_memrealtime s[88:89]
ds_read_b64 v[252:253], v21 offset:15904
v_dot2_f32_bf16 v32, v128, v8, 0
v_dot2_f32_bf16 v32, v129, v9, v32
v_dot2_f32_bf16 v32, v130, v10, v32
v_dot2_f32_bf16 v32, v131, v11, v32
s_waitcnt vmcnt(6)
s_cbranch_vccnz L_fb137
s_waitcnt vmcnt(4)
L_fb137:
buffer_load_dwordx4 v[160:163], v1, s[8:11], s39 offen offset:256 nt
s_waitcnt lgkmcnt(0)
v_mov_b32 v255, 2141
v_mul_u32_u24 v253, v255, v253
v_mov_b32 v254, s88
v_lshrrev_b32 v253, 12, v253
ds_write_b64 v21, v[254:255] offset:15872
v_add_u32 v253, v253, v252
v_sub_u32 v253, v254, v253
v_cmp_lt_i32 vcc, 0, v253
v_dot2_f32_bf16 v32, v132, v12, v32
v_dot2_f32_bf16 v32, v133, v13, v32
v_dot2_f32_bf16 v32, v134, v14, v32
v_dot2_f32_bf16 v32, v135, v15, v32
s_waitcnt vmcnt(6)
s_cbranch_vccnz L_fb138
s_waitcnt vmcnt(4)
L_fb138:
s_add_u32 s39, s7, 4521984
buffer_load_dwordx4 v[164:167], v1, s[8:11], s39 offen offset:0 nt
v_dot2_f32_bf16 v32, v136, v16, v32
v_dot2_f32_bf16 v32, v137, v17, v32
v_dot2_f32_bf16 v32, v138, v18, v32
v_dot2_f32_bf16 v32, v139, v19, v32
s_nop 2
v_add_f32_dpp v33, v32, v32 quad_perm:[1,0,3,2] row_mask:0xf bank_mask:0xf
s_nop 1
v_add_f32_dpp v33, v33, v33 quad_perm:[2,3,0,1] row_mask:0xf bank_mask:0xf
s_nop 1
v_add_f32_dpp v33, v33, v33 row_half_mirror row_mask:0xf bank_mask:0xf
v_cvt_pk_bf16_f32 v33, v33, v33
v_and_b32 v33, s60, v33
v_mul_f32 v33, s61, v33
v_cvt_pk_bf16_f32 v33, v33, v33
v_and_b32 v83, s60, v33
v_max_f32 v2, v2, v83
s_waitcnt vmcnt(6)
s_cbranch_vccnz L_fb139
s_waitcnt vmcnt(4)
L_fb139:
buffer_load_dwordx4 v[168:171], v1, s[8:11], s39 offen offset:128 nt
v_dot2_f32_bf16 v32, v140, v8, 0
v_dot2_f32_bf16 v32, v141, v9, v32
v_dot2_f32_bf16 v32, v142, v10, v32
v_dot2_f32_bf16 v32, v143, v11, v32
s_waitcnt vmcnt(6)
s_cbranch_vccnz L_fb140
s_waitcnt vmcnt(4)
L_fb140:
buffer_load_dwordx4 v[172:175], v1, s[8:11], s39 offen offset:256 nt
v_dot2_f32_bf16 v32, v144, v12, v32
v_dot2_f32_bf16 v32, v145, v13, v32
v_dot2_f32_bf16 v32, v146, v14, v32
v_dot2_f32_bf16 v32, v147, v15, v32
s_waitcnt vmcnt(6)
s_cbranch_vccnz L_fb141
s_waitcnt vmcnt(4)
L_fb141:
s_add_u32 s39, s7, 4620288
buffer_load_dwordx4 v[176:179], v1, s[8:11], s39 offen offset:0 nt
v_dot2_f32_bf16 v32, v148, v16, v32
v_dot2_f32_bf16 v32, v149, v17, v32
v_dot2_f32_bf16 v32, v150, v18, v32
v_dot2_f32_bf16 v32, v151, v19, v32
s_nop 2
v_add_f32_dpp v33, v32, v32 quad_perm:[1,0,3,2] row_mask:0xf bank_mask:0xf
s_nop 1
v_add_f32_dpp v33, v33, v33 quad_perm:[2,3,0,1] row_mask:0xf bank_mask:0xf
s_nop 1
v_add_f32_dpp v33, v33, v33 row_half_mirror row_mask:0xf bank_mask:0xf
v_cvt_pk_bf16_f32 v33, v33, v33
v_and_b32 v33, s60, v33
v_mul_f32 v33, s61, v33
v_cvt_pk_bf16_f32 v33, v33, v33
v_and_b32 v84, s60, v33
v_max_f32 v2, v2, v84
s_waitcnt vmcnt(6)
s_cbranch_vccnz L_fb142
s_waitcnt vmcnt(4)
L_fb142:
buffer_load_dwordx4 v[180:183], v1, s[8:11], s39 offen offset:128 nt
s_memrealtime s[88:89]
ds_read_b64 v[252:253], v21 offset:15904
v_dot2_f32_bf16 v32, v152, v8, 0
v_dot2_f32_bf16 v32, v153, v9, v32
v_dot2_f32_bf16 v32, v154, v10, v32
v_dot2_f32_bf16 v32, v155, v11, v32
s_waitcnt vmcnt(6)
s_cbranch_vccnz L_fb143
s_waitcnt vmcnt(4)
L_fb143:
buffer_load_dwordx4 v[184:187], v1, s[8:11], s39 offen offset:256 nt
s_waitcnt lgkmcnt(0)
v_mov_b32 v255, 2222
v_mul_u32_u24 v253, v255, v253
v_mov_b32 v254, s88
v_lshrrev_b32 v253, 12, v253
ds_write_b64 v21, v[254:255] offset:15872
v_add_u32 v253, v253, v252
v_sub_u32 v253, v254, v253
v_cmp_lt_i32 vcc, 0, v253
v_dot2_f32_bf16 v32, v156, v12, v32
v_dot2_f32_bf16 v32, v157, v13, v32
v_dot2_f32_bf16 v32, v158, v14, v32
v_dot2_f32_bf16 v32, v159, v15, v32
s_waitcnt vmcnt(6)
s_cbranch_vccnz L_fb144
s_waitcnt vmcnt(4)
L_fb144:
s_add_u32 s39, s7, 4718592
buffer_load_dwordx4 v[188:191], v1, s[8:11], s39 offen offset:0 nt
v_dot2_f32_bf16 v32, v160, v16, v32
v_dot2_f32_bf16 v32, v161, v17, v32
v_dot2_f32_bf16 v32, v162, v18, v32
v_dot2_f32_bf16 v32, v163, v19, v32
s_nop 2
v_add_f32_dpp v33, v32, v32 quad_perm:[1,0,3,2] row_mask:0xf bank_mask:0xf
s_nop 1
v_add_f32_dpp v33, v33, v33 quad_perm:[2,3,0,1] row_mask:0xf bank_mask:0xf
s_nop 1
v_add_f32_dpp v33, v33, v33 row_half_mirror row_mask:0xf bank_mask:0xf
v_cvt_pk_bf16_f32 v33, v33, v33
v_and_b32 v33, s60, v33
v_mul_f32 v33, s61, v33
v_cvt_pk_bf16_f32 v33, v33, v33
v_and_b32 v85, s60, v33
v_max_f32 v2, v2, v85
s_waitcnt vmcnt(6)
s_cbranch_vccnz L_fb145
s_waitcnt vmcnt(4)
L_fb145:
buffer_load_dwordx4 v[192:195], v1, s[8:11], s39 offen offset:128 nt
v_dot2_f32_bf16 v32, v164, v8, 0
v_dot2_f32_bf16 v32, v165, v9, v32
v_dot2_f32_bf16 v32, v166, v10, v32
v_dot2_f32_bf16 v32, v167, v11, v32
s_waitcnt vmcnt(6)
s_cbranch_vccnz L_fb146
s_waitcnt vmcnt(4)
L_fb146:
buffer_load_dwordx4 v[196:199], v1, s[8:11], s39 offen offset:256 nt
v_dot2_f32_bf16 v32, v168, v12, v32
v_dot2_f32_bf16 v32, v169, v13, v32
v_dot2_f32_bf16 v32, v170, v14, v32
v_dot2_f32_bf16 v32, v171, v15, v32
s_waitcnt vmcnt(6)
s_cbranch_vccnz L_fb147
s_waitcnt vmcnt(4)
L_fb147:
s_add_u32 s39, s7, 4816896
buffer_load_dwordx4 v[200:203], v1, s[8:11], s39 offen offset:0 nt
v_dot2_f32_bf16 v32, v172, v16, v32
v_dot2_f32_bf16 v32, v173, v17, v32
v_dot2_f32_bf16 v32, v174, v18, v32
v_dot2_f32_bf16 v32, v175, v19, v32
s_nop 2
v_add_f32_dpp v33, v32, v32 quad_perm:[1,0,3,2] row_mask:0xf bank_mask:0xf
s_nop 1
v_add_f32_dpp v33, v33, v33 quad_perm:[2,3,0,1] row_mask:0xf bank_mask:0xf
s_nop 1
v_add_f32_dpp v33, v33, v33 row_half_mirror row_mask:0xf bank_mask:0xf
v_cvt_pk_bf16_f32 v33, v33, v33
v_and_b32 v33, s60, v33
v_mul_f32 v33, s61, v33
v_cvt_pk_bf16_f32 v33, v33, v33
v_and_b32 v86, s60, v33
v_max_f32 v2, v2, v86
s_waitcnt vmcnt(6)
s_cbranch_vccnz L_fb148
s_waitcnt vmcnt(4)
L_fb148:
buffer_load_dwordx4 v[204:207], v1, s[8:11], s39 offen offset:128 nt
s_memrealtime s[88:89]
ds_read_b64 v[252:253], v21 offset:15904
v_dot2_f32_bf16 v32, v176, v8, 0
v_dot2_f32_bf16 v32, v177, v9, v32
v_dot2_f32_bf16 v32, v178, v10, v32
v_dot2_f32_bf16 v32, v179, v11, v32
s_waitcnt vmcnt(6)
s_cbranch_vccnz L_fb149
s_waitcnt vmcnt(4)
L_fb149:
buffer_load_dwordx4 v[208:211], v1, s[8:11], s39 offen offset:256 nt
s_waitcnt lgkmcnt(0)
v_mov_b32 v255, 2304
v_mul_u32_u24 v253, v255, v253
v_mov_b32 v254, s88
v_lshrrev_b32 v253, 12, v253
ds_write_b64 v21, v[254:255] offset:15872
v_add_u32 v253, v253, v252
v_sub_u32 v253, v254, v253
v_cmp_lt_i32 vcc, 0, v253
v_dot2_f32_bf16 v32, v180, v12, v32
v_dot2_f32_bf16 v32, v181, v13, v32
v_dot2_f32_bf16 v32, v182, v14, v32
v_dot2_f32_bf16 v32, v183, v15, v32
s_waitcnt vmcnt(6)
s_cbranch_vccnz L_fb150
s_waitcnt vmcnt(4)
L_fb150:
s_add_u32 s39, s7, 4915200
buffer_load_dwordx4 v[212:215], v1, s[8:11], s39 offen offset:0 nt
v_dot2_f32_bf16 v32, v184, v16, v32
v_dot2_f32_bf16 v32, v185, v17, v32
v_dot2_f32_bf16 v32, v186, v18, v32
v_dot2_f32_bf16 v32, v187, v19, v32
s_nop 2
v_add_f32_dpp v33, v32, v32 quad_perm:[1,0,3,2] row_mask:0xf bank_mask:0xf
s_nop 1
v_add_f32_dpp v33, v33, v33 quad_perm:[2,3,0,1] row_mask:0xf bank_mask:0xf
s_nop 1
v_add_f32_dpp v33, v33, v33 row_half_mirror row_mask:0xf bank_mask:0xf
v_cvt_pk_bf16_f32 v33, v33, v33
v_and_b32 v33, s60, v33
v_mul_f32 v33, s61, v33
v_cvt_pk_bf16_f32 v33, v33, v33
v_and_b32 v87, s60, v33
v_max_f32 v2, v2, v87
s_waitcnt vmcnt(6)
s_cbranch_vccnz L_fb151
s_waitcnt vmcnt(4)
L_fb151:
buffer_load_dwordx4 v[216:219], v1, s[8:11], s39 offen offset:128 nt
v_dot2_f32_bf16 v32, v188, v8, 0
v_dot2_f32_bf16 v32, v189, v9, v32
v_dot2_f32_bf16 v32, v190, v10, v32
v_dot2_f32_bf16 v32, v191, v11, v32
s_waitcnt vmcnt(6)
s_cbranch_vccnz L_fb152
s_waitcnt vmcnt(4)
L_fb152:
buffer_load_dwordx4 v[220:223], v1, s[8:11], s39 offen offset:256 nt
v_dot2_f32_bf16 v32, v192, v12, v32
v_dot2_f32_bf16 v32, v193, v13, v32
v_dot2_f32_bf16 v32, v194, v14, v32
v_dot2_f32_bf16 v32, v195, v15, v32
s_waitcnt vmcnt(6)
s_cbranch_vccnz L_fb153
s_waitcnt vmcnt(4)
L_fb153:
s_add_u32 s39, s7, 5013504
buffer_load_dwordx4 v[224:227], v1, s[8:11], s39 offen offset:0 nt
v_dot2_f32_bf16 v32, v196, v16, v32
v_dot2_f32_bf16 v32, v197, v17, v32
v_dot2_f32_bf16 v32, v198, v18, v32
v_dot2_f32_bf16 v32, v199, v19, v32
s_nop 2
v_add_f32_dpp v33, v32, v32 quad_perm:[1,0,3,2] row_mask:0xf bank_mask:0xf
s_nop 1
v_add_f32_dpp v33, v33, v33 quad_perm:[2,3,0,1] row_mask:0xf bank_mask:0xf
s_nop 1
v_add_f32_dpp v33, v33, v33 row_half_mirror row_mask:0xf bank_mask:0xf
v_cvt_pk_bf16_f32 v33, v33, v33
v_and_b32 v33, s60, v33
v_mul_f32 v33, s61, v33
v_cvt_pk_bf16_f32 v33, v33, v33
v_and_b32 v88, s60, v33
v_max_f32 v2, v2, v88
s_waitcnt vmcnt(6)
s_cbranch_vccnz L_fb154
s_waitcnt vmcnt(4)
L_fb154:
buffer_load_dwordx4 v[228:231], v1, s[8:11], s39 offen offset:128 nt
s_memrealtime s[88:89]
ds_read_b64 v[252:253], v21 offset:15904
v_dot2_f32_bf16 v32, v200, v8, 0
v_dot2_f32_bf16 v32, v201, v9, v32
v_dot2_f32_bf16 v32, v202, v10, v32
v_dot2_f32_bf16 v32, v203, v11, v32
s_waitcnt vmcnt(6)
s_cbranch_vccnz L_fb155
s_waitcnt vmcnt(4)
L_fb155:
buffer_load_dwordx4 v[232:235], v1, s[8:11], s39 offen offset:256 nt
s_waitcnt lgkmcnt(0)
v_mov_b32 v255, 2385
v_mul_u32_u24 v253, v255, v253
v_mov_b32 v254, s88
v_lshrrev_b32 v253, 12, v253
ds_write_b64 v21, v[254:255] offset:15872
v_add_u32 v253, v253, v252
v_sub_u32 v253, v254, v253
v_cmp_lt_i32 vcc, 0, v253
v_dot2_f32_bf16 v32, v204, v12, v32
v_dot2_f32_bf16 v32, v205, v13, v32
v_dot2_f32_bf16 v32, v206, v14, v32
v_dot2_f32_bf16 v32, v207, v15, v32
s_waitcnt vmcnt(6)
s_cbranch_vccnz L_fb156
s_waitcnt vmcnt(4)
L_fb156:
s_add_u32 s39, s7, 5111808
buffer_load_dwordx4 v[236:239], v1, s[8:11], s39 offen offset:0 nt
v_dot2_f32_bf16 v32, v208, v16, v32
v_dot2_f32_bf16 v32, v209, v17, v32
v_dot2_f32_bf16 v32, v210, v18, v32
v_dot2_f32_bf16 v32, v211, v19, v32
s_nop 2
v_add_f32_dpp v33, v32, v32 quad_perm:[1,0,3,2] row_mask:0xf bank_mask:0xf
s_nop 1
v_add_f32_dpp v33, v33, v33 quad_perm:[2,3,0,1] row_mask:0xf bank_mask:0xf
s_nop 1
v_add_f32_dpp v33, v33, v33 row_half_mirror row_mask:0xf bank_mask:0xf
v_cvt_pk_bf16_f32 v33, v33, v33
v_and_b32 v33, s60, v33
v_mul_f32 v33, s61, v33
v_cvt_pk_bf16_f32 v33, v33, v33
v_and_b32 v89, s60, v33
v_max_f32 v2, v2, v89
s_waitcnt vmcnt(6)
s_cbranch_vccnz L_fb157
s_waitcnt vmcnt(4)
L_fb157:
buffer_load_dwordx4 v[240:243], v1, s[8:11], s39 offen offset:128 nt
v_dot2_f32_bf16 v32, v212, v8, 0
v_dot2_f32_bf16 v32, v213, v9, v32
v_dot2_f32_bf16 v32, v214, v10, v32
v_dot2_f32_bf16 v32, v215, v11, v32
s_waitcnt vmcnt(6)
s_cbranch_vccnz L_fb158
s_waitcnt vmcnt(4)
L_fb158:
buffer_load_dwordx4 v[244:247], v1, s[8:11], s39 offen offset:256 nt
v_dot2_f32_bf16 v32, v216, v12, v32
v_dot2_f32_bf16 v32, v217, v13, v32
v_dot2_f32_bf16 v32, v218, v14, v32
v_dot2_f32_bf16 v32, v219, v15, v32
s_waitcnt vmcnt(6)
s_cbranch_vccnz L_fb159
s_waitcnt vmcnt(4)
L_fb159:
s_add_u32 s39, s7, 5210112
buffer_load_dwordx4 v[248:251], v1, s[8:11], s39 offen offset:0 nt
v_dot2_f32_bf16 v32, v220, v16, v32
v_dot2_f32_bf16 v32, v221, v17, v32
v_dot2_f32_bf16 v32, v222, v18, v32
v_dot2_f32_bf16 v32, v223, v19, v32
s_nop 2
v_add_f32_dpp v33, v32, v32 quad_perm:[1,0,3,2] row_mask:0xf bank_mask:0xf
s_nop 1
v_add_f32_dpp v33, v33, v33 quad_perm:[2,3,0,1] row_mask:0xf bank_mask:0xf
s_nop 1
v_add_f32_dpp v33, v33, v33 row_half_mirror row_mask:0xf bank_mask:0xf
v_cvt_pk_bf16_f32 v33, v33, v33
v_and_b32 v33, s60, v33
v_mul_f32 v33, s61, v33
v_cvt_pk_bf16_f32 v33, v33, v33
v_and_b32 v90, s60, v33
v_max_f32 v2, v2, v90
s_waitcnt vmcnt(6)
s_cbranch_vccnz L_fb160
s_waitcnt vmcnt(4)
L_fb160:
buffer_load_dwordx4 v[104:107], v1, s[8:11], s39 offen offset:128 nt
s_memrealtime s[88:89]
ds_read_b64 v[252:253], v21 offset:15904
v_dot2_f32_bf16 v32, v224, v8, 0
v_dot2_f32_bf16 v32, v225, v9, v32
v_dot2_f32_bf16 v32, v226, v10, v32
v_dot2_f32_bf16 v32, v227, v11, v32
s_waitcnt vmcnt(6)
s_cbranch_vccnz L_fb161
s_waitcnt vmcnt(4)
L_fb161:
buffer_load_dwordx4 v[108:111], v1, s[8:11], s39 offen offset:256 nt
s_waitcnt lgkmcnt(0)
v_mov_b32 v255, 2466
v_mul_u32_u24 v253, v255, v253
v_mov_b32 v254, s88
v_lshrrev_b32 v253, 12, v253
ds_write_b64 v21, v[254:255] offset:15872
v_add_u32 v253, v253, v252
v_sub_u32 v253, v254, v253
v_cmp_lt_i32 vcc, 0, v253
v_dot2_f32_bf16 v32, v228, v12, v32
v_dot2_f32_bf16 v32, v229, v13, v32
v_dot2_f32_bf16 v32, v230, v14, v32
v_dot2_f32_bf16 v32, v231, v15, v32
s_waitcnt vmcnt(6)
s_cbranch_vccnz L_fb162
s_waitcnt vmcnt(4)
L_fb162:
s_add_u32 s39, s7, 5308416
buffer_load_dwordx4 v[112:115], v1, s[8:11], s39 offen offset:0 nt
v_dot2_f32_bf16 v32, v232, v16, v32
v_dot2_f32_bf16 v32, v233, v17, v32
v_dot2_f32_bf16 v32, v234, v18, v32
v_dot2_f32_bf16 v32, v235, v19, v32
s_nop 2
v_add_f32_dpp v33, v32, v32 quad_perm:[1,0,3,2] row_mask:0xf bank_mask:0xf
s_nop 1
v_add_f32_dpp v33, v33, v33 quad_perm:[2,3,0,1] row_mask:0xf bank_mask:0xf
s_nop 1
v_add_f32_dpp v33, v33, v33 row_half_mirror row_mask:0xf bank_mask:0xf
v_cvt_pk_bf16_f32 v33, v33, v33
v_and_b32 v33, s60, v33
v_mul_f32 v33, s61, v33
v_cvt_pk_bf16_f32 v33, v33, v33
v_and_b32 v91, s60, v33
v_max_f32 v2, v2, v91
s_waitcnt vmcnt(6)
s_cbranch_vccnz L_fb163
s_waitcnt vmcnt(4)
L_fb163:
buffer_load_dwordx4 v[116:119], v1, s[8:11], s39 offen offset:128 nt
v_dot2_f32_bf16 v32, v236, v8, 0
v_dot2_f32_bf16 v32, v237, v9, v32
v_dot2_f32_bf16 v32, v238, v10, v32
v_dot2_f32_bf16 v32, v239, v11, v32
s_waitcnt vmcnt(6)
s_cbranch_vccnz L_fb164
s_waitcnt vmcnt(4)
L_fb164:
buffer_load_dwordx4 v[120:123], v1, s[8:11], s39 offen offset:256 nt
v_dot2_f32_bf16 v32, v240, v12, v32
v_dot2_f32_bf16 v32, v241, v13, v32
v_dot2_f32_bf16 v32, v242, v14, v32
v_dot2_f32_bf16 v32, v243, v15, v32
s_waitcnt vmcnt(6)
s_cbranch_vccnz L_fb165
s_waitcnt vmcnt(4)
L_fb165:
s_add_u32 s39, s7, 5406720
buffer_load_dwordx4 v[124:127], v1, s[8:11], s39 offen offset:0 nt
v_dot2_f32_bf16 v32, v244, v16, v32
v_dot2_f32_bf16 v32, v245, v17, v32
v_dot2_f32_bf16 v32, v246, v18, v32
v_dot2_f32_bf16 v32, v247, v19, v32
s_nop 2
v_add_f32_dpp v33, v32, v32 quad_perm:[1,0,3,2] row_mask:0xf bank_mask:0xf
s_nop 1
v_add_f32_dpp v33, v33, v33 quad_perm:[2,3,0,1] row_mask:0xf bank_mask:0xf
s_nop 1
v_add_f32_dpp v33, v33, v33 row_half_mirror row_mask:0xf bank_mask:0xf
v_cvt_pk_bf16_f32 v33, v33, v33
v_and_b32 v33, s60, v33
v_mul_f32 v33, s61, v33
v_cvt_pk_bf16_f32 v33, v33, v33
v_and_b32 v92, s60, v33
v_max_f32 v2, v2, v92
s_waitcnt vmcnt(6)
s_cbranch_vccnz L_fb166
s_waitcnt vmcnt(4)
L_fb166:
buffer_load_dwordx4 v[128:131], v1, s[8:11], s39 offen offset:128 nt
s_memrealtime s[88:89]
ds_read_b64 v[252:253], v21 offset:15904
v_dot2_f32_bf16 v32, v248, v8, 0
v_dot2_f32_bf16 v32, v249, v9, v32
v_dot2_f32_bf16 v32, v250, v10, v32
v_dot2_f32_bf16 v32, v251, v11, v32
s_waitcnt vmcnt(6)
s_cbranch_vccnz L_fb167
s_waitcnt vmcnt(4)
L_fb167:
buffer_load_dwordx4 v[132:135], v1, s[8:11], s39 offen offset:256 nt
s_waitcnt lgkmcnt(0)
v_mov_b32 v255, 2547
v_mul_u32_u24 v253, v255, v253
v_mov_b32 v254, s88
v_lshrrev_b32 v253, 12, v253
ds_write_b64 v21, v[254:255] offset:15872
v_add_u32 v253, v253, v252
v_sub_u32 v253, v254, v253
v_cmp_lt_i32 vcc, 0, v253
v_dot2_f32_bf16 v32, v104, v12, v32
v_dot2_f32_bf16 v32, v105, v13, v32
v_dot2_f32_bf16 v32, v106, v14, v32
v_dot2_f32_bf16 v32, v107, v15, v32
s_waitcnt vmcnt(6)
s_cbranch_vccnz L_fb168
s_waitcnt vmcnt(4)
L_fb168:
s_add_u32 s39, s7, 5505024
buffer_load_dwordx4 v[136:139], v1, s[8:11], s39 offen offset:0 nt
v_dot2_f32_bf16 v32, v108, v16, v32
v_dot2_f32_bf16 v32, v109, v17, v32
v_dot2_f32_bf16 v32, v110, v18, v32
v_dot2_f32_bf16 v32, v111, v19, v32
s_nop 2
v_add_f32_dpp v33, v32, v32 quad_perm:[1,0,3,2] row_mask:0xf bank_mask:0xf
s_nop 1
v_add_f32_dpp v33, v33, v33 quad_perm:[2,3,0,1] row_mask:0xf bank_mask:0xf
s_nop 1
v_add_f32_dpp v33, v33, v33 row_half_mirror row_mask:0xf bank_mask:0xf
v_cvt_pk_bf16_f32 v33, v33, v33
v_and_b32 v33, s60, v33
v_mul_f32 v33, s61, v33
v_cvt_pk_bf16_f32 v33, v33, v33
v_and_b32 v93, s60, v33
v_max_f32 v2, v2, v93
s_waitcnt vmcnt(6)
s_cbranch_vccnz L_fb169
s_waitcnt vmcnt(4)
L_fb169:
buffer_load_dwordx4 v[140:143], v1, s[8:11], s39 offen offset:128 nt
v_dot2_f32_bf16 v32, v112, v8, 0
v_dot2_f32_bf16 v32, v113, v9, v32
v_dot2_f32_bf16 v32, v114, v10, v32
v_dot2_f32_bf16 v32, v115, v11, v32
s_waitcnt vmcnt(6)
s_cbranch_vccnz L_fb170
s_waitcnt vmcnt(4)
L_fb170:
buffer_load_dwordx4 v[144:147], v1, s[8:11], s39 offen offset:256 nt
v_dot2_f32_bf16 v32, v116, v12, v32
v_dot2_f32_bf16 v32, v117, v13, v32
v_dot2_f32_bf16 v32, v118, v14, v32
v_dot2_f32_bf16 v32, v119, v15, v32
s_waitcnt vmcnt(6)
s_cbranch_vccnz L_fb171
s_waitcnt vmcnt(4)
L_fb171:
s_add_u32 s39, s7, 5603328
buffer_load_dwordx4 v[148:151], v1, s[8:11], s39 offen offset:0 nt
v_dot2_f32_bf16 v32, v120, v16, v32
v_dot2_f32_bf16 v32, v121, v17, v32
v_dot2_f32_bf16 v32, v122, v18, v32
v_dot2_f32_bf16 v32, v123, v19, v32
s_nop 2
v_add_f32_dpp v33, v32, v32 quad_perm:[1,0,3,2] row_mask:0xf bank_mask:0xf
s_nop 1
v_add_f32_dpp v33, v33, v33 quad_perm:[2,3,0,1] row_mask:0xf bank_mask:0xf
s_nop 1
v_add_f32_dpp v33, v33, v33 row_half_mirror row_mask:0xf bank_mask:0xf
v_cvt_pk_bf16_f32 v33, v33, v33
v_and_b32 v33, s60, v33
v_mul_f32 v33, s61, v33
v_cvt_pk_bf16_f32 v33, v33, v33
v_and_b32 v94, s60, v33
v_max_f32 v2, v2, v94
s_waitcnt vmcnt(6)
s_cbranch_vccnz L_fb172
s_waitcnt vmcnt(4)
L_fb172:
buffer_load_dwordx4 v[152:155], v1, s[8:11], s39 offen offset:128 nt
s_memrealtime s[88:89]
ds_read_b64 v[252:253], v21 offset:15904
v_dot2_f32_bf16 v32, v124, v8, 0
v_dot2_f32_bf16 v32, v125, v9, v32
v_dot2_f32_bf16 v32, v126, v10, v32
v_dot2_f32_bf16 v32, v127, v11, v32
s_waitcnt vmcnt(6)
s_cbranch_vccnz L_fb173
s_waitcnt vmcnt(4)
L_fb173:
buffer_load_dwordx4 v[156:159], v1, s[8:11], s39 offen offset:256 nt
s_waitcnt lgkmcnt(0)
v_mov_b32 v255, 2628
v_mul_u32_u24 v253, v255, v253
v_mov_b32 v254, s88
v_lshrrev_b32 v253, 12, v253
ds_write_b64 v21, v[254:255] offset:15872
v_add_u32 v253, v253, v252
v_sub_u32 v253, v254, v253
v_cmp_lt_i32 vcc, 0, v253
v_dot2_f32_bf16 v32, v128, v12, v32
v_dot2_f32_bf16 v32, v129, v13, v32
v_dot2_f32_bf16 v32, v130, v14, v32
v_dot2_f32_bf16 v32, v131, v15, v32
s_waitcnt vmcnt(6)
s_cbranch_vccnz L_fb174
s_waitcnt vmcnt(4)
L_fb174:
s_add_u32 s39, s7, 5701632
buffer_load_dwordx4 v[160:163], v1, s[8:11], s39 offen offset:0 nt
v_dot2_f32_bf16 v32, v132, v16, v32
v_dot2_f32_bf16 v32, v133, v17, v32
v_dot2_f32_bf16 v32, v134, v18, v32
v_dot2_f32_bf16 v32, v135, v19, v32
s_nop 2
v_add_f32_dpp v33, v32, v32 quad_perm:[1,0,3,2] row_mask:0xf bank_mask:0xf
s_nop 1
v_add_f32_dpp v33, v33, v33 quad_perm:[2,3,0,1] row_mask:0xf bank_mask:0xf
s_nop 1
v_add_f32_dpp v33, v33, v33 row_half_mirror row_mask:0xf bank_mask:0xf
v_cvt_pk_bf16_f32 v33, v33, v33
v_and_b32 v33, s60, v33
v_mul_f32 v33, s61, v33
v_cvt_pk_bf16_f32 v33, v33, v33
v_and_b32 v95, s60, v33
v_max_f32 v2, v2, v95
s_waitcnt vmcnt(6)
s_cbranch_vccnz L_fb175
s_waitcnt vmcnt(4)
L_fb175:
buffer_load_dwordx4 v[164:167], v1, s[8:11], s39 offen offset:128 nt
v_dot2_f32_bf16 v32, v136, v8, 0
v_dot2_f32_bf16 v32, v137, v9, v32
v_dot2_f32_bf16 v32, v138, v10, v32
v_dot2_f32_bf16 v32, v139, v11, v32
s_waitcnt vmcnt(6)
s_cbranch_vccnz L_fb176
s_waitcnt vmcnt(4)
L_fb176:
buffer_load_dwordx4 v[168:171], v1, s[8:11], s39 offen offset:256 nt
v_dot2_f32_bf16 v32, v140, v12, v32
v_dot2_f32_bf16 v32, v141, v13, v32
v_dot2_f32_bf16 v32, v142, v14, v32
v_dot2_f32_bf16 v32, v143, v15, v32
s_waitcnt vmcnt(6)
s_cbranch_vccnz L_fb177
s_waitcnt vmcnt(4)
L_fb177:
s_add_u32 s39, s7, 5799936
buffer_load_dwordx4 v[172:175], v1, s[8:11], s39 offen offset:0 nt
v_dot2_f32_bf16 v32, v144, v16, v32
v_dot2_f32_bf16 v32, v145, v17, v32
v_dot2_f32_bf16 v32, v146, v18, v32
v_dot2_f32_bf16 v32, v147, v19, v32
s_nop 2
v_add_f32_dpp v33, v32, v32 quad_perm:[1,0,3,2] row_mask:0xf bank_mask:0xf
s_nop 1
v_add_f32_dpp v33, v33, v33 quad_perm:[2,3,0,1] row_mask:0xf bank_mask:0xf
s_nop 1
v_add_f32_dpp v33, v33, v33 row_half_mirror row_mask:0xf bank_mask:0xf
v_cvt_pk_bf16_f32 v33, v33, v33
v_and_b32 v33, s60, v33
v_mul_f32 v33, s61, v33
v_cvt_pk_bf16_f32 v33, v33, v33
v_and_b32 v96, s60, v33
v_max_f32 v2, v2, v96
s_waitcnt vmcnt(6)
s_cbranch_vccnz L_fb178
s_waitcnt vmcnt(4)
L_fb178:
buffer_load_dwordx4 v[176:179], v1, s[8:11], s39 offen offset:128 nt
s_memrealtime s[88:89]
ds_read_b64 v[252:253], v21 offset:15904
v_dot2_f32_bf16 v32, v148, v8, 0
v_dot2_f32_bf16 v32, v149, v9, v32
v_dot2_f32_bf16 v32, v150, v10, v32
v_dot2_f32_bf16 v32, v151, v11, v32
s_waitcnt vmcnt(6)
s_cbranch_vccnz L_fb179
s_waitcnt vmcnt(4)
L_fb179:
buffer_load_dwordx4 v[180:183], v1, s[8:11], s39 offen offset:256 nt
s_waitcnt lgkmcnt(0)
v_mov_b32 v255, 2709
v_mul_u32_u24 v253, v255, v253
v_mov_b32 v254, s88
v_lshrrev_b32 v253, 12, v253
ds_write_b64 v21, v[254:255] offset:15872
v_add_u32 v253, v253, v252
v_sub_u32 v253, v254, v253
v_cmp_lt_i32 vcc, 0, v253
v_dot2_f32_bf16 v32, v152, v12, v32
v_dot2_f32_bf16 v32, v153, v13, v32
v_dot2_f32_bf16 v32, v154, v14, v32
v_dot2_f32_bf16 v32, v155, v15, v32
s_waitcnt vmcnt(6)
s_cbranch_vccnz L_fb180
s_waitcnt vmcnt(4)
L_fb180:
s_add_u32 s39, s7, 5898240
buffer_load_dwordx4 v[184:187], v1, s[8:11], s39 offen offset:0 nt
v_dot2_f32_bf16 v32, v156, v16, v32
v_dot2_f32_bf16 v32, v157, v17, v32
v_dot2_f32_bf16 v32, v158, v18, v32
v_dot2_f32_bf16 v32, v159, v19, v32
s_nop 2
v_add_f32_dpp v33, v32, v32 quad_perm:[1,0,3,2] row_mask:0xf bank_mask:0xf
s_nop 1
v_add_f32_dpp v33, v33, v33 quad_perm:[2,3,0,1] row_mask:0xf bank_mask:0xf
s_nop 1
v_add_f32_dpp v33, v33, v33 row_half_mirror row_mask:0xf bank_mask:0xf
v_cvt_pk_bf16_f32 v33, v33, v33
v_and_b32 v33, s60, v33
v_mul_f32 v33, s61, v33
v_cvt_pk_bf16_f32 v33, v33, v33
v_and_b32 v97, s60, v33
v_max_f32 v2, v2, v97
s_waitcnt vmcnt(6)
s_cbranch_vccnz L_fb181
s_waitcnt vmcnt(4)
L_fb181:
buffer_load_dwordx4 v[188:191], v1, s[8:11], s39 offen offset:128 nt
v_dot2_f32_bf16 v32, v160, v8, 0
v_dot2_f32_bf16 v32, v161, v9, v32
v_dot2_f32_bf16 v32, v162, v10, v32
v_dot2_f32_bf16 v32, v163, v11, v32
s_waitcnt vmcnt(6)
s_cbranch_vccnz L_fb182
s_waitcnt vmcnt(4)
L_fb182:
buffer_load_dwordx4 v[192:195], v1, s[8:11], s39 offen offset:256 nt
v_dot2_f32_bf16 v32, v164, v12, v32
v_dot2_f32_bf16 v32, v165, v13, v32
v_dot2_f32_bf16 v32, v166, v14, v32
v_dot2_f32_bf16 v32, v167, v15, v32
s_waitcnt vmcnt(6)
s_cbranch_vccnz L_fb183
s_waitcnt vmcnt(4)
L_fb183:
s_add_u32 s39, s7, 5996544
buffer_load_dwordx4 v[196:199], v1, s[8:11], s39 offen offset:0 nt
v_dot2_f32_bf16 v32, v168, v16, v32
v_dot2_f32_bf16 v32, v169, v17, v32
v_dot2_f32_bf16 v32, v170, v18, v32
v_dot2_f32_bf16 v32, v171, v19, v32
s_nop 2
v_add_f32_dpp v33, v32, v32 quad_perm:[1,0,3,2] row_mask:0xf bank_mask:0xf
s_nop 1
v_add_f32_dpp v33, v33, v33 quad_perm:[2,3,0,1] row_mask:0xf bank_mask:0xf
s_nop 1
v_add_f32_dpp v33, v33, v33 row_half_mirror row_mask:0xf bank_mask:0xf
v_cvt_pk_bf16_f32 v33, v33, v33
v_and_b32 v33, s60, v33
v_mul_f32 v33, s61, v33
v_cvt_pk_bf16_f32 v33, v33, v33
v_and_b32 v98, s60, v33
v_max_f32 v2, v2, v98
s_waitcnt vmcnt(6)
s_cbranch_vccnz L_fb184
s_waitcnt vmcnt(4)
L_fb184:
buffer_load_dwordx4 v[200:203], v1, s[8:11], s39 offen offset:128 nt
s_memrealtime s[88:89]
ds_read_b64 v[252:253], v21 offset:15904
v_dot2_f32_bf16 v32, v172, v8, 0
v_dot2_f32_bf16 v32, v173, v9, v32
v_dot2_f32_bf16 v32, v174, v10, v32
v_dot2_f32_bf16 v32, v175, v11, v32
s_waitcnt vmcnt(6)
s_cbranch_vccnz L_fb185
s_waitcnt vmcnt(4)
L_fb185:
buffer_load_dwordx4 v[204:207], v1, s[8:11], s39 offen offset:256 nt
s_waitcnt lgkmcnt(0)
v_mov_b32 v255, 2790
v_mul_u32_u24 v253, v255, v253
v_mov_b32 v254, s88
v_lshrrev_b32 v253, 12, v253
ds_write_b64 v21, v[254:255] offset:15872
v_add_u32 v253, v253, v252
v_sub_u32 v253, v254, v253
v_cmp_lt_i32 vcc, 0, v253
v_dot2_f32_bf16 v32, v176, v12, v32
v_dot2_f32_bf16 v32, v177, v13, v32
v_dot2_f32_bf16 v32, v178, v14, v32
v_dot2_f32_bf16 v32, v179, v15, v32
s_waitcnt vmcnt(6)
s_cbranch_vccnz L_fb186
s_waitcnt vmcnt(4)
L_fb186:
s_add_u32 s39, s7, 6094848
buffer_load_dwordx4 v[208:211], v1, s[8:11], s39 offen offset:0 nt
v_dot2_f32_bf16 v32, v180, v16, v32
v_dot2_f32_bf16 v32, v181, v17, v32
v_dot2_f32_bf16 v32, v182, v18, v32
v_dot2_f32_bf16 v32, v183, v19, v32
s_nop 2
v_add_f32_dpp v33, v32, v32 quad_perm:[1,0,3,2] row_mask:0xf bank_mask:0xf
s_nop 1
v_add_f32_dpp v33, v33, v33 quad_perm:[2,3,0,1] row_mask:0xf bank_mask:0xf
s_nop 1
v_add_f32_dpp v33, v33, v33 row_half_mirror row_mask:0xf bank_mask:0xf
v_cvt_pk_bf16_f32 v33, v33, v33
v_and_b32 v33, s60, v33
v_mul_f32 v33, s61, v33
v_cvt_pk_bf16_f32 v33, v33, v33
v_and_b32 v99, s60, v33
v_max_f32 v2, v2, v99
s_waitcnt vmcnt(6)
s_cbranch_vccnz L_fb187
s_waitcnt vmcnt(4)
L_fb187:
buffer_load_dwordx4 v[212:215], v1, s[8:11], s39 offen offset:128 nt
v_dot2_f32_bf16 v32, v184, v8, 0
v_dot2_f32_bf16 v32, v185, v9, v32
v_dot2_f32_bf16 v32, v186, v10, v32
v_dot2_f32_bf16 v32, v187, v11, v32
s_waitcnt vmcnt(6)
s_cbranch_vccnz L_fb188
s_waitcnt vmcnt(4)
L_fb188:
buffer_load_dwordx4 v[216:219], v1, s[8:11], s39 offen offset:256 nt
v_dot2_f32_bf16 v32, v188, v12, v32
v_dot2_f32_bf16 v32, v189, v13, v32
v_dot2_f32_bf16 v32, v190, v14, v32
v_dot2_f32_bf16 v32, v191, v15, v32
s_waitcnt vmcnt(6)
s_cbranch_vccnz L_fb189
s_waitcnt vmcnt(4)
L_fb189:
s_add_u32 s39, s7, 6193152
buffer_load_dwordx4 v[220:223], v1, s[8:11], s39 offen offset:0 nt
v_dot2_f32_bf16 v32, v192, v16, v32
v_dot2_f32_bf16 v32, v193, v17, v32
v_dot2_f32_bf16 v32, v194, v18, v32
v_dot2_f32_bf16 v32, v195, v19, v32
s_nop 2
v_add_f32_dpp v33, v32, v32 quad_perm:[1,0,3,2] row_mask:0xf bank_mask:0xf
s_nop 1
v_add_f32_dpp v33, v33, v33 quad_perm:[2,3,0,1] row_mask:0xf bank_mask:0xf
s_nop 1
v_add_f32_dpp v33, v33, v33 row_half_mirror row_mask:0xf bank_mask:0xf
v_cvt_pk_bf16_f32 v33, v33, v33
v_and_b32 v33, s60, v33
v_mul_f32 v33, s61, v33
v_cvt_pk_bf16_f32 v33, v33, v33
v_and_b32 v100, s60, v33
v_max_f32 v2, v2, v100
s_waitcnt vmcnt(6)
s_cbranch_vccnz L_fb190
s_waitcnt vmcnt(4)
L_fb190:
buffer_load_dwordx4 v[224:227], v1, s[8:11], s39 offen offset:128 nt
s_memrealtime s[88:89]
ds_read_b64 v[252:253], v21 offset:15904
v_dot2_f32_bf16 v32, v196, v8, 0
v_dot2_f32_bf16 v32, v197, v9, v32
v_dot2_f32_bf16 v32, v198, v10, v32
v_dot2_f32_bf16 v32, v199, v11, v32
s_waitcnt vmcnt(6)
s_cbranch_vccnz L_fb191
s_waitcnt vmcnt(4)
L_fb191:
buffer_load_dwordx4 v[228:231], v1, s[8:11], s39 offen offset:256 nt
s_waitcnt lgkmcnt(0)
v_mov_b32 v255, 2871
v_mul_u32_u24 v253, v255, v253
v_mov_b32 v254, s88
v_lshrrev_b32 v253, 12, v253
ds_write_b64 v21, v[254:255] offset:15872
v_add_u32 v253, v253, v252
v_sub_u32 v253, v254, v253
v_cmp_lt_i32 vcc, 0, v253
v_dot2_f32_bf16 v32, v200, v12, v32
v_dot2_f32_bf16 v32, v201, v13, v32
v_dot2_f32_bf16 v32, v202, v14, v32
v_dot2_f32_bf16 v32, v203, v15, v32
s_waitcnt vmcnt(6)
s_cbranch_vccnz L_fb192
s_waitcnt vmcnt(4)
L_fb192:
s_add_u32 s39, s7, 0
buffer_load_dwordx4 v[232:235], v1, s[12:15], s39 offen offset:0 nt
v_dot2_f32_bf16 v32, v204, v16, v32
v_dot2_f32_bf16 v32, v205, v17, v32
v_dot2_f32_bf16 v32, v206, v18, v32
v_dot2_f32_bf16 v32, v207, v19, v32
s_nop 2
v_add_f32_dpp v33, v32, v32 quad_perm:[1,0,3,2] row_mask:0xf bank_mask:0xf
s_nop 1
v_add_f32_dpp v33, v33, v33 quad_perm:[2,3,0,1] row_mask:0xf bank_mask:0xf
s_nop 1
v_add_f32_dpp v33, v33, v33 row_half_mirror row_mask:0xf bank_mask:0xf
v_cvt_pk_bf16_f32 v33, v33, v33
v_and_b32 v33, s60, v33
v_mul_f32 v33, s61, v33
v_cvt_pk_bf16_f32 v33, v33, v33
v_and_b32 v101, s60, v33
v_max_f32 v2, v2, v101
s_waitcnt vmcnt(6)
s_cbranch_vccnz L_fb193
s_waitcnt vmcnt(4)
L_fb193:
buffer_load_dwordx4 v[236:239], v1, s[12:15], s39 offen offset:128 nt
v_dot2_f32_bf16 v32, v208, v8, 0
v_dot2_f32_bf16 v32, v209, v9, v32
v_dot2_f32_bf16 v32, v210, v10, v32
v_dot2_f32_bf16 v32, v211, v11, v32
s_waitcnt vmcnt(6)
s_cbranch_vccnz L_fb194
s_waitcnt vmcnt(4)
L_fb194:
buffer_load_dwordx4 v[240:243], v1, s[12:15], s39 offen offset:256 nt
v_dot2_f32_bf16 v32, v212, v12, v32
v_dot2_f32_bf16 v32, v213, v13, v32
v_dot2_f32_bf16 v32, v214, v14, v32
v_dot2_f32_bf16 v32, v215, v15, v32
s_waitcnt vmcnt(6)
s_cbranch_vccnz L_fb195
s_waitcnt vmcnt(4)
L_fb195:
s_add_u32 s39, s7, 98304
buffer_load_dwordx4 v[244:247], v1, s[12:15], s39 offen offset:0 nt
v_dot2_f32_bf16 v32, v216, v16, v32
v_dot2_f32_bf16 v32, v217, v17, v32
v_dot2_f32_bf16 v32, v218, v18, v32
v_dot2_f32_bf16 v32, v219, v19, v32
s_nop 2
v_add_f32_dpp v33, v32, v32 quad_perm:[1,0,3,2] row_mask:0xf bank_mask:0xf
s_nop 1
v_add_f32_dpp v33, v33, v33 quad_perm:[2,3,0,1] row_mask:0xf bank_mask:0xf
s_nop 1
v_add_f32_dpp v33, v33, v33 row_half_mirror row_mask:0xf bank_mask:0xf
v_cvt_pk_bf16_f32 v33, v33, v33
v_and_b32 v33, s60, v33
v_mul_f32 v33, s61, v33
v_cvt_pk_bf16_f32 v33, v33, v33
v_and_b32 v102, s60, v33
v_max_f32 v2, v2, v102
s_waitcnt vmcnt(6)
s_cbranch_vccnz L_fb196
s_waitcnt vmcnt(4)
L_fb196:
buffer_load_dwordx4 v[248:251], v1, s[12:15], s39 offen offset:128 nt
s_memrealtime s[88:89]
ds_read_b64 v[252:253], v21 offset:15904
v_dot2_f32_bf16 v32, v220, v8, 0
v_dot2_f32_bf16 v32, v221, v9, v32
v_dot2_f32_bf16 v32, v222, v10, v32
v_dot2_f32_bf16 v32, v223, v11, v32
s_waitcnt vmcnt(6)
s_cbranch_vccnz L_fb197
s_waitcnt vmcnt(4)
L_fb197:
buffer_load_dwordx4 v[104:107], v1, s[12:15], s39 offen offset:256 nt
s_waitcnt lgkmcnt(0)
v_mov_b32 v255, 2952
v_mul_u32_u24 v253, v255, v253
v_mov_b32 v254, s88
v_lshrrev_b32 v253, 12, v253
ds_write_b64 v21, v[254:255] offset:15872
v_add_u32 v253, v253, v252
v_sub_u32 v253, v254, v253
v_cmp_lt_i32 vcc, 0, v253
v_dot2_f32_bf16 v32, v224, v12, v32
v_dot2_f32_bf16 v32, v225, v13, v32
v_dot2_f32_bf16 v32, v226, v14, v32
v_dot2_f32_bf16 v32, v227, v15, v32
s_waitcnt vmcnt(6)
s_cbranch_vccnz L_fb198
s_waitcnt vmcnt(4)
L_fb198:
s_add_u32 s39, s7, 196608
buffer_load_dwordx4 v[108:111], v1, s[12:15], s39 offen offset:0 nt
v_dot2_f32_bf16 v32, v228, v16, v32
v_dot2_f32_bf16 v32, v229, v17, v32
v_dot2_f32_bf16 v32, v230, v18, v32
v_dot2_f32_bf16 v32, v231, v19, v32
s_nop 2
v_add_f32_dpp v33, v32, v32 quad_perm:[1,0,3,2] row_mask:0xf bank_mask:0xf
s_nop 1
v_add_f32_dpp v33, v33, v33 quad_perm:[2,3,0,1] row_mask:0xf bank_mask:0xf
s_nop 1
v_add_f32_dpp v33, v33, v33 row_half_mirror row_mask:0xf bank_mask:0xf
v_cvt_pk_bf16_f32 v33, v33, v33
v_and_b32 v33, s60, v33
v_mul_f32 v33, s61, v33
v_cvt_pk_bf16_f32 v33, v33, v33
v_and_b32 v103, s60, v33
v_max_f32 v2, v2, v103
s_nop 1
v_max_f32_dpp v2, v2, v2 row_ror:8 row_mask:0xf bank_mask:0xf
v_mov_b32 v33, v2
s_nop 1
v_permlane16_swap_b32 v33, v2
v_max_f32 v2, v33, v2
v_mov_b32 v33, v2
s_nop 1
v_permlane32_swap_b32 v33, v2
v_max_f32 v2, v33, v2
v_mul_f32 v2, s62, v2
v_fma_f32 v33, v40, s62, -v2
v_exp_f32 v33, v33
s_nop 0
v_add_f32 v3, v3, v33
v_cvt_pk_bf16_f32 v33, v33, v33
v_and_b32 v28, v33, v4
v_and_b32 v29, v33, v5
v_and_b32 v30, v33, v6
v_and_b32 v31, v33, v7
s_nop 1
s_waitcnt vmcnt(6)
s_cbranch_vccnz L_fb199
s_waitcnt vmcnt(4)
L_fb199:
buffer_load_dwordx4 v[112:115], v1, s[12:15], s39 offen offset:128 nt
v_mfma_f32_16x16x32_bf16 v[8:11], v[28:31], v[232:235], 0
s_waitcnt vmcnt(6)
s_cbranch_vccnz L_fb200
s_waitcnt vmcnt(4)
L_fb200:
buffer_load_dwordx4 v[116:119], v1, s[12:15], s39 offen offset:256 nt
v_mfma_f32_16x16x32_bf16 v[12:15], v[28:31], v[236:239], 0
s_waitcnt vmcnt(6)
s_cbranch_vccnz L_fb201
s_waitcnt vmcnt(4)
L_fb201:
s_add_u32 s39, s7, 294912
buffer_load_dwordx4 v[120:123], v1, s[12:15], s39 offen offset:0 nt
v_mfma_f32_16x16x32_bf16 v[16:19], v[28:31], v[240:243], 0
v_fma_f32 v33, v41, s62, -v2
v_exp_f32 v33, v33
s_nop 0
v_add_f32 v3, v3, v33
v_cvt_pk_bf16_f32 v33, v33, v33
v_and_b32 v28, v33, v4
v_and_b32 v29, v33, v5
v_and_b32 v30, v33, v6
v_and_b32 v31, v33, v7
s_nop 1
s_waitcnt vmcnt(6)
s_cbranch_vccnz L_fb202
s_waitcnt vmcnt(4)
L_fb202:
buffer_load_dwordx4 v[124:127], v1, s[12:15], s39 offen offset:128 nt
s_memrealtime s[88:89]
ds_read_b64 v[252:253], v21 offset:15904
v_mfma_f32_16x16x32_bf16 v[8:11], v[28:31], v[244:247], v[8:11]
s_waitcnt vmcnt(6)
s_cbranch_vccnz L_fb203
s_waitcnt vmcnt(4)
L_fb203:
buffer_load_dwordx4 v[128:131], v1, s[12:15], s39 offen offset:256 nt
s_waitcnt lgkmcnt(0)
v_mov_b32 v255, 3033
v_mul_u32_u24 v253, v255, v253
v_mov_b32 v254, s88
v_lshrrev_b32 v253, 12, v253
ds_write_b64 v21, v[254:255] offset:15872
v_add_u32 v253, v253, v252
v_sub_u32 v253, v254, v253
v_cmp_lt_i32 vcc, 0, v253
v_mfma_f32_16x16x32_bf16 v[12:15], v[28:31], v[248:251], v[12:15]
s_waitcnt vmcnt(6)
s_cbranch_vccnz L_fb204
s_waitcnt vmcnt(4)
L_fb204:
s_add_u32 s39, s7, 393216
buffer_load_dwordx4 v[132:135], v1, s[12:15], s39 offen offset:0 nt
v_mfma_f32_16x16x32_bf16 v[16:19], v[28:31], v[104:107], v[16:19]
v_fma_f32 v33, v42, s62, -v2
v_exp_f32 v33, v33
s_nop 0
v_add_f32 v3, v3, v33
v_cvt_pk_bf16_f32 v33, v33, v33
v_and_b32 v28, v33, v4
v_and_b32 v29, v33, v5
v_and_b32 v30, v33, v6
v_and_b32 v31, v33, v7
s_nop 1
s_waitcnt vmcnt(6)
s_cbranch_vccnz L_fb205
s_waitcnt vmcnt(4)
L_fb205:
buffer_load_dwordx4 v[136:139], v1, s[12:15], s39 offen offset:128 nt
v_mfma_f32_16x16x32_bf16 v[8:11], v[28:31], v[108:111], v[8:11]
s_waitcnt vmcnt(6)
s_cbranch_vccnz L_fb206
s_waitcnt vmcnt(4)
L_fb206:
buffer_load_dwordx4 v[140:143], v1, s[12:15], s39 offen offset:256 nt
v_mfma_f32_16x16x32_bf16 v[12:15], v[28:31], v[112:115], v[12:15]
s_waitcnt vmcnt(6)
s_cbranch_vccnz L_fb207
s_waitcnt vmcnt(4)
L_fb207:
s_add_u32 s39, s7, 491520
buffer_load_dwordx4 v[144:147], v1, s[12:15], s39 offen offset:0 nt
v_mfma_f32_16x16x32_bf16 v[16:19], v[28:31], v[116:119], v[16:19]
v_fma_f32 v33, v43, s62, -v2
v_exp_f32 v33, v33
s_nop 0
v_add_f32 v3, v3, v33
v_cvt_pk_bf16_f32 v33, v33, v33
v_and_b32 v28, v33, v4
v_and_b32 v29, v33, v5
v_and_b32 v30, v33, v6
v_and_b32 v31, v33, v7
s_nop 1
s_waitcnt vmcnt(6)
s_cbranch_vccnz L_fb208
s_waitcnt vmcnt(4)
L_fb208:
buffer_load_dwordx4 v[148:151], v1, s[12:15], s39 offen offset:128 nt
s_memrealtime s[88:89]
ds_read_b64 v[252:253], v21 offset:15904
v_mfma_f32_16x16x32_bf16 v[8:11], v[28:31], v[120:123], v[8:11]
s_waitcnt vmcnt(6)
s_cbranch_vccnz L_fb209
s_waitcnt vmcnt(4)
L_fb209:
buffer_load_dwordx4 v[152:155], v1, s[12:15], s39 offen offset:256 nt
s_waitcnt lgkmcnt(0)
v_mov_b32 v255, 3114
v_mul_u32_u24 v253, v255, v253
v_mov_b32 v254, s88
v_lshrrev_b32 v253, 12, v253
ds_write_b64 v21, v[254:255] offset:15872
v_add_u32 v253, v253, v252
v_sub_u32 v253, v254, v253
v_cmp_lt_i32 vcc, 0, v253
v_mfma_f32_16x16x32_bf16 v[12:15], v[28:31], v[124:127], v[12:15]
s_waitcnt vmcnt(6)
s_cbranch_vccnz L_fb210
s_waitcnt vmcnt(4)
L_fb210:
s_add_u32 s39, s7, 589824
buffer_load_dwordx4 v[156:159], v1, s[12:15], s39 offen offset:0 nt
v_mfma_f32_16x16x32_bf16 v[16:19], v[28:31], v[128:131], v[16:19]
v_fma_f32 v33, v44, s62, -v2
v_exp_f32 v33, v33
s_nop 0
v_add_f32 v3, v3, v33
v_cvt_pk_bf16_f32 v33, v33, v33
v_and_b32 v28, v33, v4
v_and_b32 v29, v33, v5
v_and_b32 v30, v33, v6
v_and_b32 v31, v33, v7
s_nop 1
s_waitcnt vmcnt(6)
s_cbranch_vccnz L_fb211
s_waitcnt vmcnt(4)
L_fb211:
buffer_load_dwordx4 v[160:163], v1, s[12:15], s39 offen offset:128 nt
v_mfma_f32_16x16x32_bf16 v[8:11], v[28:31], v[132:135], v[8:11]
s_waitcnt vmcnt(6)
s_cbranch_vccnz L_fb212
s_waitcnt vmcnt(4)
L_fb212:
buffer_load_dwordx4 v[164:167], v1, s[12:15], s39 offen offset:256 nt
v_mfma_f32_16x16x32_bf16 v[12:15], v[28:31], v[136:139], v[12:15]
s_waitcnt vmcnt(6)
s_cbranch_vccnz L_fb213
s_waitcnt vmcnt(4)
L_fb213:
s_add_u32 s39, s7, 688128
buffer_load_dwordx4 v[168:171], v1, s[12:15], s39 offen offset:0 nt
v_mfma_f32_16x16x32_bf16 v[16:19], v[28:31], v[140:143], v[16:19]
v_fma_f32 v33, v45, s62, -v2
v_exp_f32 v33, v33
s_nop 0
v_add_f32 v3, v3, v33
v_cvt_pk_bf16_f32 v33, v33, v33
v_and_b32 v28, v33, v4
v_and_b32 v29, v33, v5
v_and_b32 v30, v33, v6
v_and_b32 v31, v33, v7
s_nop 1
s_waitcnt vmcnt(6)
s_cbranch_vccnz L_fb214
s_waitcnt vmcnt(4)
L_fb214:
buffer_load_dwordx4 v[172:175], v1, s[12:15], s39 offen offset:128 nt
s_memrealtime s[88:89]
ds_read_b64 v[252:253], v21 offset:15904
v_mfma_f32_16x16x32_bf16 v[8:11], v[28:31], v[144:147], v[8:11]
s_waitcnt vmcnt(6)
s_cbranch_vccnz L_fb215
s_waitcnt vmcnt(4)
L_fb215:
buffer_load_dwordx4 v[176:179], v1, s[12:15], s39 offen offset:256 nt
s_waitcnt lgkmcnt(0)
v_mov_b32 v255, 3195
v_mul_u32_u24 v253, v255, v253
v_mov_b32 v254, s88
v_lshrrev_b32 v253, 12, v253
ds_write_b64 v21, v[254:255] offset:15872
v_add_u32 v253, v253, v252
v_sub_u32 v253, v254, v253
v_cmp_lt_i32 vcc, 0, v253
v_mfma_f32_16x16x32_bf16 v[12:15], v[28:31], v[148:151], v[12:15]
s_waitcnt vmcnt(6)
s_cbranch_vccnz L_fb216
s_waitcnt vmcnt(4)
L_fb216:
s_add_u32 s39, s7, 786432
buffer_load_dwordx4 v[180:183], v1, s[12:15], s39 offen offset:0 nt
v_mfma_f32_16x16x32_bf16 v[16:19], v[28:31], v[152:155], v[16:19]
v_fma_f32 v33, v46, s62, -v2
v_exp_f32 v33, v33
s_nop 0
v_add_f32 v3, v3, v33
v_cvt_pk_bf16_f32 v33, v33, v33
v_and_b32 v28, v33, v4
v_and_b32 v29, v33, v5
v_and_b32 v30, v33, v6
v_and_b32 v31, v33, v7
s_nop 1
s_waitcnt vmcnt(6)
s_cbranch_vccnz L_fb217
s_waitcnt vmcnt(4)
L_fb217:
buffer_load_dwordx4 v[184:187], v1, s[12:15], s39 offen offset:128 nt
v_mfma_f32_16x16x32_bf16 v[8:11], v[28:31], v[156:159], v[8:11]
s_waitcnt vmcnt(6)
s_cbranch_vccnz L_fb218
s_waitcnt vmcnt(4)
L_fb218:
buffer_load_dwordx4 v[188:191], v1, s[12:15], s39 offen offset:256 nt
v_mfma_f32_16x16x32_bf16 v[12:15], v[28:31], v[160:163], v[12:15]
s_waitcnt vmcnt(6)
s_cbranch_vccnz L_fb219
s_waitcnt vmcnt(4)
L_fb219:
s_add_u32 s39, s7, 884736
buffer_load_dwordx4 v[192:195], v1, s[12:15], s39 offen offset:0 nt
v_mfma_f32_16x16x32_bf16 v[16:19], v[28:31], v[164:167], v[16:19]
v_fma_f32 v33, v47, s62, -v2
v_exp_f32 v33, v33
s_nop 0
v_add_f32 v3, v3, v33
v_cvt_pk_bf16_f32 v33, v33, v33
v_and_b32 v28, v33, v4
v_and_b32 v29, v33, v5
v_and_b32 v30, v33, v6
v_and_b32 v31, v33, v7
s_nop 1
s_waitcnt vmcnt(6)
s_cbranch_vccnz L_fb220
s_waitcnt vmcnt(4)
L_fb220:
buffer_load_dwordx4 v[196:199], v1, s[12:15], s39 offen offset:128 nt
s_memrealtime s[88:89]
ds_read_b64 v[252:253], v21 offset:15904
v_mfma_f32_16x16x32_bf16 v[8:11], v[28:31], v[168:171], v[8:11]
s_waitcnt vmcnt(6)
s_cbranch_vccnz L_fb221
s_waitcnt vmcnt(4)
L_fb221:
buffer_load_dwordx4 v[200:203], v1, s[12:15], s39 offen offset:256 nt
s_waitcnt lgkmcnt(0)
v_mov_b32 v255, 3276
v_mul_u32_u24 v253, v255, v253
v_mov_b32 v254, s88
v_lshrrev_b32 v253, 12, v253
ds_write_b64 v21, v[254:255] offset:15872
v_add_u32 v253, v253, v252
v_sub_u32 v253, v254, v253
v_cmp_lt_i32 vcc, 0, v253
v_mfma_f32_16x16x32_bf16 v[12:15], v[28:31], v[172:175], v[12:15]
s_waitcnt vmcnt(6)
s_cbranch_vccnz L_fb222
s_waitcnt vmcnt(4)
L_fb222:
s_add_u32 s39, s7, 983040
buffer_load_dwordx4 v[204:207], v1, s[12:15], s39 offen offset:0 nt
v_mfma_f32_16x16x32_bf16 v[16:19], v[28:31], v[176:179], v[16:19]
v_fma_f32 v33, v48, s62, -v2
v_exp_f32 v33, v33
s_nop 0
v_add_f32 v3, v3, v33
v_cvt_pk_bf16_f32 v33, v33, v33
v_and_b32 v28, v33, v4
v_and_b32 v29, v33, v5
v_and_b32 v30, v33, v6
v_and_b32 v31, v33, v7
s_nop 1
s_waitcnt vmcnt(6)
s_cbranch_vccnz L_fb223
s_waitcnt vmcnt(4)
L_fb223:
buffer_load_dwordx4 v[208:211], v1, s[12:15], s39 offen offset:128 nt
v_mfma_f32_16x16x32_bf16 v[8:11], v[28:31], v[180:183], v[8:11]
s_waitcnt vmcnt(6)
s_cbranch_vccnz L_fb224
s_waitcnt vmcnt(4)
L_fb224:
buffer_load_dwordx4 v[212:215], v1, s[12:15], s39 offen offset:256 nt
v_mfma_f32_16x16x32_bf16 v[12:15], v[28:31], v[184:187], v[12:15]
s_waitcnt vmcnt(6)
s_cbranch_vccnz L_fb225
s_waitcnt vmcnt(4)
L_fb225:
s_add_u32 s39, s7, 1081344
buffer_load_dwordx4 v[216:219], v1, s[12:15], s39 offen offset:0 nt
v_mfma_f32_16x16x32_bf16 v[16:19], v[28:31], v[188:191], v[16:19]
v_fma_f32 v33, v49, s62, -v2
v_exp_f32 v33, v33
s_nop 0
v_add_f32 v3, v3, v33
v_cvt_pk_bf16_f32 v33, v33, v33
v_and_b32 v28, v33, v4
v_and_b32 v29, v33, v5
v_and_b32 v30, v33, v6
v_and_b32 v31, v33, v7
s_nop 1
s_waitcnt vmcnt(6)
s_cbranch_vccnz L_fb226
s_waitcnt vmcnt(4)
L_fb226:
buffer_load_dwordx4 v[220:223], v1, s[12:15], s39 offen offset:128 nt
s_memrealtime s[88:89]
ds_read_b64 v[252:253], v21 offset:15904
v_mfma_f32_16x16x32_bf16 v[8:11], v[28:31], v[192:195], v[8:11]
s_waitcnt vmcnt(6)
s_cbranch_vccnz L_fb227
s_waitcnt vmcnt(4)
L_fb227:
buffer_load_dwordx4 v[224:227], v1, s[12:15], s39 offen offset:256 nt
s_waitcnt lgkmcnt(0)
v_mov_b32 v255, 3357
v_mul_u32_u24 v253, v255, v253
v_mov_b32 v254, s88
v_lshrrev_b32 v253, 12, v253
ds_write_b64 v21, v[254:255] offset:15872
v_add_u32 v253, v253, v252
v_sub_u32 v253, v254, v253
v_cmp_lt_i32 vcc, 0, v253
v_mfma_f32_16x16x32_bf16 v[12:15], v[28:31], v[196:199], v[12:15]
s_waitcnt vmcnt(6)
s_cbranch_vccnz L_fb228
s_waitcnt vmcnt(4)
L_fb228:
s_add_u32 s39, s7, 1179648
buffer_load_dwordx4 v[228:231], v1, s[12:15], s39 offen offset:0 nt
v_mfma_f32_16x16x32_bf16 v[16:19], v[28:31], v[200:203], v[16:19]
v_fma_f32 v33, v50, s62, -v2
v_exp_f32 v33, v33
s_nop 0
v_add_f32 v3, v3, v33
v_cvt_pk_bf16_f32 v33, v33, v33
v_and_b32 v28, v33, v4
v_and_b32 v29, v33, v5
v_and_b32 v30, v33, v6
v_and_b32 v31, v33, v7
s_nop 1
s_waitcnt vmcnt(6)
s_cbranch_vccnz L_fb229
s_waitcnt vmcnt(4)
L_fb229:
buffer_load_dwordx4 v[232:235], v1, s[12:15], s39 offen offset:128 nt
v_mfma_f32_16x16x32_bf16 v[8:11], v[28:31], v[204:207], v[8:11]
s_waitcnt vmcnt(6)
s_cbranch_vccnz L_fb230
s_waitcnt vmcnt(4)
L_fb230:
buffer_load_dwordx4 v[236:239], v1, s[12:15], s39 offen offset:256 nt
v_mfma_f32_16x16x32_bf16 v[12:15], v[28:31], v[208:211], v[12:15]
s_waitcnt vmcnt(6)
s_cbranch_vccnz L_fb231
s_waitcnt vmcnt(4)
L_fb231:
s_add_u32 s39, s7, 1277952
buffer_load_dwordx4 v[240:243], v1, s[12:15], s39 offen offset:0 nt
v_mfma_f32_16x16x32_bf16 v[16:19], v[28:31], v[212:215], v[16:19]
v_fma_f32 v33, v51, s62, -v2
v_exp_f32 v33, v33
s_nop 0
v_add_f32 v3, v3, v33
v_cvt_pk_bf16_f32 v33, v33, v33
v_and_b32 v28, v33, v4
v_and_b32 v29, v33, v5
v_and_b32 v30, v33, v6
v_and_b32 v31, v33, v7
s_nop 1
s_waitcnt vmcnt(6)
s_cbranch_vccnz L_fb232
s_waitcnt vmcnt(4)
L_fb232:
buffer_load_dwordx4 v[244:247], v1, s[12:15], s39 offen offset:128 nt
s_memrealtime s[88:89]
ds_read_b64 v[252:253], v21 offset:15904
v_mfma_f32_16x16x32_bf16 v[8:11], v[28:31], v[216:219], v[8:11]
s_waitcnt vmcnt(6)
s_cbranch_vccnz L_fb233
s_waitcnt vmcnt(4)
L_fb233:
buffer_load_dwordx4 v[248:251], v1, s[12:15], s39 offen offset:256 nt
s_waitcnt lgkmcnt(0)
v_mov_b32 v255, 3438
v_mul_u32_u24 v253, v255, v253
v_mov_b32 v254, s88
v_lshrrev_b32 v253, 12, v253
ds_write_b64 v21, v[254:255] offset:15872
v_add_u32 v253, v253, v252
v_sub_u32 v253, v254, v253
v_cmp_lt_i32 vcc, 0, v253
v_mfma_f32_16x16x32_bf16 v[12:15], v[28:31], v[220:223], v[12:15]
s_waitcnt vmcnt(6)
s_cbranch_vccnz L_fb234
s_waitcnt vmcnt(4)
L_fb234:
s_add_u32 s39, s7, 1376256
buffer_load_dwordx4 v[104:107], v1, s[12:15], s39 offen offset:0 nt
v_mfma_f32_16x16x32_bf16 v[16:19], v[28:31], v[224:227], v[16:19]
v_fma_f32 v33, v52, s62, -v2
v_exp_f32 v33, v33
s_nop 0
v_add_f32 v3, v3, v33
v_cvt_pk_bf16_f32 v33, v33, v33
v_and_b32 v28, v33, v4
v_and_b32 v29, v33, v5
v_and_b32 v30, v33, v6
v_and_b32 v31, v33, v7
s_nop 1
s_waitcnt vmcnt(6)
s_cbranch_vccnz L_fb235
s_waitcnt vmcnt(4)
L_fb235:
buffer_load_dwordx4 v[108:111], v1, s[12:15], s39 offen offset:128 nt
v_mfma_f32_16x16x32_bf16 v[8:11], v[28:31], v[228:231], v[8:11]
s_waitcnt vmcnt(6)
s_cbranch_vccnz L_fb236
s_waitcnt vmcnt(4)
L_fb236:
buffer_load_dwordx4 v[112:115], v1, s[12:15], s39 offen offset:256 nt
v_mfma_f32_16x16x32_bf16 v[12:15], v[28:31], v[232:235], v[12:15]
s_waitcnt vmcnt(6)
s_cbranch_vccnz L_fb237
s_waitcnt vmcnt(4)
L_fb237:
s_add_u32 s39, s7, 1474560
buffer_load_dwordx4 v[116:119], v1, s[12:15], s39 offen offset:0 nt
v_mfma_f32_16x16x32_bf16 v[16:19], v[28:31], v[236:239], v[16:19]
v_fma_f32 v33, v53, s62, -v2
v_exp_f32 v33, v33
s_nop 0
v_add_f32 v3, v3, v33
v_cvt_pk_bf16_f32 v33, v33, v33
v_and_b32 v28, v33, v4
v_and_b32 v29, v33, v5
v_and_b32 v30, v33, v6
v_and_b32 v31, v33, v7
s_nop 1
s_waitcnt vmcnt(6)
s_cbranch_vccnz L_fb238
s_waitcnt vmcnt(4)
L_fb238:
buffer_load_dwordx4 v[120:123], v1, s[12:15], s39 offen offset:128 nt
s_memrealtime s[88:89]
ds_read_b64 v[252:253], v21 offset:15904
v_mfma_f32_16x16x32_bf16 v[8:11], v[28:31], v[240:243], v[8:11]
s_waitcnt vmcnt(6)
s_cbranch_vccnz L_fb239
s_waitcnt vmcnt(4)
L_fb239:
buffer_load_dwordx4 v[124:127], v1, s[12:15], s39 offen offset:256 nt
s_waitcnt lgkmcnt(0)
v_mov_b32 v255, 3519
v_mul_u32_u24 v253, v255, v253
v_mov_b32 v254, s88
v_lshrrev_b32 v253, 12, v253
ds_write_b64 v21, v[254:255] offset:15872
v_add_u32 v253, v253, v252
v_sub_u32 v253, v254, v253
v_cmp_lt_i32 vcc, 0, v253
v_mfma_f32_16x16x32_bf16 v[12:15], v[28:31], v[244:247], v[12:15]
s_waitcnt vmcnt(6)
s_cbranch_vccnz L_fb240
s_waitcnt vmcnt(4)
L_fb240:
s_add_u32 s39, s7, 1572864
buffer_load_dwordx4 v[128:131], v1, s[12:15], s39 offen offset:0 nt
v_mfma_f32_16x16x32_bf16 v[16:19], v[28:31], v[248:251], v[16:19]
v_fma_f32 v33, v54, s62, -v2
v_exp_f32 v33, v33
s_nop 0
v_add_f32 v3, v3, v33
v_cvt_pk_bf16_f32 v33, v33, v33
v_and_b32 v28, v33, v4
v_and_b32 v29, v33, v5
v_and_b32 v30, v33, v6
v_and_b32 v31, v33, v7
s_nop 1
s_waitcnt vmcnt(6)
s_cbranch_vccnz L_fb241
s_waitcnt vmcnt(4)
L_fb241:
buffer_load_dwordx4 v[132:135], v1, s[12:15], s39 offen offset:128 nt
v_mfma_f32_16x16x32_bf16 v[8:11], v[28:31], v[104:107], v[8:11]
s_waitcnt vmcnt(6)
s_cbranch_vccnz L_fb242
s_waitcnt vmcnt(4)
L_fb242:
buffer_load_dwordx4 v[136:139], v1, s[12:15], s39 offen offset:256 nt
v_mfma_f32_16x16x32_bf16 v[12:15], v[28:31], v[108:111], v[12:15]
s_waitcnt vmcnt(6)
s_cbranch_vccnz L_fb243
s_waitcnt vmcnt(4)
L_fb243:
s_add_u32 s39, s7, 1671168
buffer_load_dwordx4 v[140:143], v1, s[12:15], s39 offen offset:0 nt
v_mfma_f32_16x16x32_bf16 v[16:19], v[28:31], v[112:115], v[16:19]
v_fma_f32 v33, v55, s62, -v2
v_exp_f32 v33, v33
s_nop 0
v_add_f32 v3, v3, v33
v_cvt_pk_bf16_f32 v33, v33, v33
v_and_b32 v28, v33, v4
v_and_b32 v29, v33, v5
v_and_b32 v30, v33, v6
v_and_b32 v31, v33, v7
s_nop 1
s_waitcnt vmcnt(6)
s_cbranch_vccnz L_fb244
s_waitcnt vmcnt(4)
L_fb244:
buffer_load_dwordx4 v[144:147], v1, s[12:15], s39 offen offset:128 nt
s_memrealtime s[88:89]
ds_read_b64 v[252:253], v21 offset:15904
v_mfma_f32_16x16x32_bf16 v[8:11], v[28:31], v[116:119], v[8:11]
s_waitcnt vmcnt(6)
s_cbranch_vccnz L_fb245
s_waitcnt vmcnt(4)
L_fb245:
buffer_load_dwordx4 v[148:151], v1, s[12:15], s39 offen offset:256 nt
s_waitcnt lgkmcnt(0)
v_mov_b32 v255, 3601
v_mul_u32_u24 v253, v255, v253
v_mov_b32 v254, s88
v_lshrrev_b32 v253, 12, v253
ds_write_b64 v21, v[254:255] offset:15872
v_add_u32 v253, v253, v252
v_sub_u32 v253, v254, v253
v_cmp_lt_i32 vcc, 0, v253
v_mfma_f32_16x16x32_bf16 v[12:15], v[28:31], v[120:123], v[12:15]
s_waitcnt vmcnt(6)
s_cbranch_vccnz L_fb246
s_waitcnt vmcnt(4)
L_fb246:
s_add_u32 s39, s7, 1769472
buffer_load_dwordx4 v[152:155], v1, s[12:15], s39 offen offset:0 nt
v_mfma_f32_16x16x32_bf16 v[16:19], v[28:31], v[124:127], v[16:19]
v_fma_f32 v33, v56, s62, -v2
v_exp_f32 v33, v33
s_nop 0
v_add_f32 v3, v3, v33
v_cvt_pk_bf16_f32 v33, v33, v33
v_and_b32 v28, v33, v4
v_and_b32 v29, v33, v5
v_and_b32 v30, v33, v6
v_and_b32 v31, v33, v7
s_nop 1
s_waitcnt vmcnt(6)
s_cbranch_vccnz L_fb247
s_waitcnt vmcnt(4)
L_fb247:
buffer_load_dwordx4 v[156:159], v1, s[12:15], s39 offen offset:128 nt
v_mfma_f32_16x16x32_bf16 v[8:11], v[28:31], v[128:131], v[8:11]
s_waitcnt vmcnt(6)
s_cbranch_vccnz L_fb248
s_waitcnt vmcnt(4)
L_fb248:
buffer_load_dwordx4 v[160:163], v1, s[12:15], s39 offen offset:256 nt
v_mfma_f32_16x16x32_bf16 v[12:15], v[28:31], v[132:135], v[12:15]
s_waitcnt vmcnt(6)
s_cbranch_vccnz L_fb249
s_waitcnt vmcnt(4)
L_fb249:
s_add_u32 s39, s7, 1867776
buffer_load_dwordx4 v[164:167], v1, s[12:15], s39 offen offset:0 nt
v_mfma_f32_16x16x32_bf16 v[16:19], v[28:31], v[136:139], v[16:19]
v_fma_f32 v33, v57, s62, -v2
v_exp_f32 v33, v33
s_nop 0
v_add_f32 v3, v3, v33
v_cvt_pk_bf16_f32 v33, v33, v33
v_and_b32 v28, v33, v4
v_and_b32 v29, v33, v5
v_and_b32 v30, v33, v6
v_and_b32 v31, v33, v7
s_nop 1
s_waitcnt vmcnt(6)
s_cbranch_vccnz L_fb250
s_waitcnt vmcnt(4)
L_fb250:
buffer_load_dwordx4 v[168:171], v1, s[12:15], s39 offen offset:128 nt
s_memrealtime s[88:89]
ds_read_b64 v[252:253], v21 offset:15904
v_mfma_f32_16x16x32_bf16 v[8:11], v[28:31], v[140:143], v[8:11]
s_waitcnt vmcnt(6)
s_cbranch_vccnz L_fb251
s_waitcnt vmcnt(4)
L_fb251:
buffer_load_dwordx4 v[172:175], v1, s[12:15], s39 offen offset:256 nt
s_waitcnt lgkmcnt(0)
v_mov_b32 v255, 3682
v_mul_u32_u24 v253, v255, v253
v_mov_b32 v254, s88
v_lshrrev_b32 v253, 12, v253
ds_write_b64 v21, v[254:255] offset:15872
v_add_u32 v253, v253, v252
v_sub_u32 v253, v254, v253
v_cmp_lt_i32 vcc, 0, v253
v_mfma_f32_16x16x32_bf16 v[12:15], v[28:31], v[144:147], v[12:15]
s_waitcnt vmcnt(6)
s_cbranch_vccnz L_fb252
s_waitcnt vmcnt(4)
L_fb252:
s_add_u32 s39, s7, 1966080
buffer_load_dwordx4 v[176:179], v1, s[12:15], s39 offen offset:0 nt
v_mfma_f32_16x16x32_bf16 v[16:19], v[28:31], v[148:151], v[16:19]
v_fma_f32 v33, v58, s62, -v2
v_exp_f32 v33, v33
s_nop 0
v_add_f32 v3, v3, v33
v_cvt_pk_bf16_f32 v33, v33, v33
v_and_b32 v28, v33, v4
v_and_b32 v29, v33, v5
v_and_b32 v30, v33, v6
v_and_b32 v31, v33, v7
s_nop 1
s_waitcnt vmcnt(6)
s_cbranch_vccnz L_fb253
s_waitcnt vmcnt(4)
L_fb253:
buffer_load_dwordx4 v[180:183], v1, s[12:15], s39 offen offset:128 nt
v_mfma_f32_16x16x32_bf16 v[8:11], v[28:31], v[152:155], v[8:11]
s_waitcnt vmcnt(6)
s_cbranch_vccnz L_fb254
s_waitcnt vmcnt(4)
L_fb254:
buffer_load_dwordx4 v[184:187], v1, s[12:15], s39 offen offset:256 nt
v_mfma_f32_16x16x32_bf16 v[12:15], v[28:31], v[156:159], v[12:15]
s_waitcnt vmcnt(6)
s_cbranch_vccnz L_fb255
s_waitcnt vmcnt(4)
L_fb255:
s_add_u32 s39, s7, 2064384
buffer_load_dwordx4 v[188:191], v1, s[12:15], s39 offen offset:0 nt
v_mfma_f32_16x16x32_bf16 v[16:19], v[28:31], v[160:163], v[16:19]
v_fma_f32 v33, v59, s62, -v2
v_exp_f32 v33, v33
s_nop 0
v_add_f32 v3, v3, v33
v_cvt_pk_bf16_f32 v33, v33, v33
v_and_b32 v28, v33, v4
v_and_b32 v29, v33, v5
v_and_b32 v30, v33, v6
v_and_b32 v31, v33, v7
s_nop 1
s_waitcnt vmcnt(6)
s_cbranch_vccnz L_fb256
s_waitcnt vmcnt(4)
L_fb256:
buffer_load_dwordx4 v[192:195], v1, s[12:15], s39 offen offset:128 nt
s_memrealtime s[88:89]
ds_read_b64 v[252:253], v21 offset:15904
v_mfma_f32_16x16x32_bf16 v[8:11], v[28:31], v[164:167], v[8:11]
s_waitcnt vmcnt(6)
s_cbranch_vccnz L_fb257
s_waitcnt vmcnt(4)
L_fb257:
buffer_load_dwordx4 v[196:199], v1, s[12:15], s39 offen offset:256 nt
s_waitcnt lgkmcnt(0)
v_mov_b32 v255, 3763
v_mul_u32_u24 v253, v255, v253
v_mov_b32 v254, s88
v_lshrrev_b32 v253, 12, v253
ds_write_b64 v21, v[254:255] offset:15872
v_add_u32 v253, v253, v252
v_sub_u32 v253, v254, v253
v_cmp_lt_i32 vcc, 0, v253
v_mfma_f32_16x16x32_bf16 v[12:15], v[28:31], v[168:171], v[12:15]
s_waitcnt vmcnt(6)
s_cbranch_vccnz L_fb258
s_waitcnt vmcnt(4)
L_fb258:
s_add_u32 s39, s7, 2162688
buffer_load_dwordx4 v[200:203], v1, s[12:15], s39 offen offset:0 nt
v_mfma_f32_16x16x32_bf16 v[16:19], v[28:31], v[172:175], v[16:19]
v_fma_f32 v33, v60, s62, -v2
v_exp_f32 v33, v33
s_nop 0
v_add_f32 v3, v3, v33
v_cvt_pk_bf16_f32 v33, v33, v33
v_and_b32 v28, v33, v4
v_and_b32 v29, v33, v5
v_and_b32 v30, v33, v6
v_and_b32 v31, v33, v7
s_nop 1
s_waitcnt vmcnt(6)
s_cbranch_vccnz L_fb259
s_waitcnt vmcnt(4)
L_fb259:
buffer_load_dwordx4 v[204:207], v1, s[12:15], s39 offen offset:128 nt
v_mfma_f32_16x16x32_bf16 v[8:11], v[28:31], v[176:179], v[8:11]
s_waitcnt vmcnt(6)
s_cbranch_vccnz L_fb260
s_waitcnt vmcnt(4)
L_fb260:
buffer_load_dwordx4 v[208:211], v1, s[12:15], s39 offen offset:256 nt
v_mfma_f32_16x16x32_bf16 v[12:15], v[28:31], v[180:183], v[12:15]
s_waitcnt vmcnt(6)
s_cbranch_vccnz L_fb261
s_waitcnt vmcnt(4)
L_fb261:
s_add_u32 s39, s7, 2260992
buffer_load_dwordx4 v[212:215], v1, s[12:15], s39 offen offset:0 nt
v_mfma_f32_16x16x32_bf16 v[16:19], v[28:31], v[184:187], v[16:19]
v_fma_f32 v33, v61, s62, -v2
v_exp_f32 v33, v33
s_nop 0
v_add_f32 v3, v3, v33
v_cvt_pk_bf16_f32 v33, v33, v33
v_and_b32 v28, v33, v4
v_and_b32 v29, v33, v5
v_and_b32 v30, v33, v6
v_and_b32 v31, v33, v7
s_nop 1
s_waitcnt vmcnt(6)
s_cbranch_vccnz L_fb262
s_waitcnt vmcnt(4)
L_fb262:
buffer_load_dwordx4 v[216:219], v1, s[12:15], s39 offen offset:128 nt
s_memrealtime s[88:89]
ds_read_b64 v[252:253], v21 offset:15904
v_mfma_f32_16x16x32_bf16 v[8:11], v[28:31], v[188:191], v[8:11]
s_waitcnt vmcnt(6)
s_cbranch_vccnz L_fb263
s_waitcnt vmcnt(4)
L_fb263:
buffer_load_dwordx4 v[220:223], v1, s[12:15], s39 offen offset:256 nt
s_waitcnt lgkmcnt(0)
v_mov_b32 v255, 3844
v_mul_u32_u24 v253, v255, v253
v_mov_b32 v254, s88
v_lshrrev_b32 v253, 12, v253
ds_write_b64 v21, v[254:255] offset:15872
v_add_u32 v253, v253, v252
v_sub_u32 v253, v254, v253
v_cmp_lt_i32 vcc, 0, v253
v_mfma_f32_16x16x32_bf16 v[12:15], v[28:31], v[192:195], v[12:15]
s_waitcnt vmcnt(6)
s_cbranch_vccnz L_fb264
s_waitcnt vmcnt(4)
L_fb264:
s_add_u32 s39, s7, 2359296
buffer_load_dwordx4 v[224:227], v1, s[12:15], s39 offen offset:0 nt
v_mfma_f32_16x16x32_bf16 v[16:19], v[28:31], v[196:199], v[16:19]
v_fma_f32 v33, v62, s62, -v2
v_exp_f32 v33, v33
s_nop 0
v_add_f32 v3, v3, v33
v_cvt_pk_bf16_f32 v33, v33, v33
v_and_b32 v28, v33, v4
v_and_b32 v29, v33, v5
v_and_b32 v30, v33, v6
v_and_b32 v31, v33, v7
s_nop 1
s_waitcnt vmcnt(6)
s_cbranch_vccnz L_fb265
s_waitcnt vmcnt(4)
L_fb265:
buffer_load_dwordx4 v[228:231], v1, s[12:15], s39 offen offset:128 nt
v_mfma_f32_16x16x32_bf16 v[8:11], v[28:31], v[200:203], v[8:11]
s_waitcnt vmcnt(6)
s_cbranch_vccnz L_fb266
s_waitcnt vmcnt(4)
L_fb266:
buffer_load_dwordx4 v[232:235], v1, s[12:15], s39 offen offset:256 nt
v_mfma_f32_16x16x32_bf16 v[12:15], v[28:31], v[204:207], v[12:15]
s_waitcnt vmcnt(6)
s_cbranch_vccnz L_fb267
s_waitcnt vmcnt(4)
L_fb267:
s_add_u32 s39, s7, 2457600
buffer_load_dwordx4 v[236:239], v1, s[12:15], s39 offen offset:0 nt
v_mfma_f32_16x16x32_bf16 v[16:19], v[28:31], v[208:211], v[16:19]
v_fma_f32 v33, v63, s62, -v2
v_exp_f32 v33, v33
s_nop 0
v_add_f32 v3, v3, v33
v_cvt_pk_bf16_f32 v33, v33, v33
v_and_b32 v28, v33, v4
v_and_b32 v29, v33, v5
v_and_b32 v30, v33, v6
v_and_b32 v31, v33, v7
s_nop 1
s_waitcnt vmcnt(6)
s_cbranch_vccnz L_fb268
s_waitcnt vmcnt(4)
L_fb268:
buffer_load_dwordx4 v[240:243], v1, s[12:15], s39 offen offset:128 nt
s_memrealtime s[88:89]
ds_read_b64 v[252:253], v21 offset:15904
v_mfma_f32_16x16x32_bf16 v[8:11], v[28:31], v[212:215], v[8:11]
s_waitcnt vmcnt(6)
s_cbranch_vccnz L_fb269
s_waitcnt vmcnt(4)
L_fb269:
buffer_load_dwordx4 v[244:247], v1, s[12:15], s39 offen offset:256 nt
s_waitcnt lgkmcnt(0)
v_mov_b32 v255, 3925
v_mul_u32_u24 v253, v255, v253
v_mov_b32 v254, s88
v_lshrrev_b32 v253, 12, v253
ds_write_b64 v21, v[254:255] offset:15872
v_add_u32 v253, v253, v252
v_sub_u32 v253, v254, v253
v_cmp_lt_i32 vcc, 0, v253
v_mfma_f32_16x16x32_bf16 v[12:15], v[28:31], v[216:219], v[12:15]
s_waitcnt vmcnt(6)
s_cbranch_vccnz L_fb270
s_waitcnt vmcnt(4)
L_fb270:
s_add_u32 s39, s7, 2555904
buffer_load_dwordx4 v[248:251], v1, s[12:15], s39 offen offset:0 nt
v_mfma_f32_16x16x32_bf16 v[16:19], v[28:31], v[220:223], v[16:19]
v_fma_f32 v33, v64, s62, -v2
v_exp_f32 v33, v33
s_nop 0
v_add_f32 v3, v3, v33
v_cvt_pk_bf16_f32 v33, v33, v33
v_and_b32 v28, v33, v4
v_and_b32 v29, v33, v5
v_and_b32 v30, v33, v6
v_and_b32 v31, v33, v7
s_nop 1
s_waitcnt vmcnt(6)
s_cbranch_vccnz L_fb271
s_waitcnt vmcnt(4)
L_fb271:
buffer_load_dwordx4 v[104:107], v1, s[12:15], s39 offen offset:128 nt
v_mfma_f32_16x16x32_bf16 v[8:11], v[28:31], v[224:227], v[8:11]
s_waitcnt vmcnt(6)
s_cbranch_vccnz L_fb272
s_waitcnt vmcnt(4)
L_fb272:
buffer_load_dwordx4 v[108:111], v1, s[12:15], s39 offen offset:256 nt
v_mfma_f32_16x16x32_bf16 v[12:15], v[28:31], v[228:231], v[12:15]
s_waitcnt vmcnt(6)
s_cbranch_vccnz L_fb273
s_waitcnt vmcnt(4)
L_fb273:
s_add_u32 s39, s7, 2654208
buffer_load_dwordx4 v[112:115], v1, s[12:15], s39 offen offset:0 nt
v_mfma_f32_16x16x32_bf16 v[16:19], v[28:31], v[232:235], v[16:19]
v_fma_f32 v33, v65, s62, -v2
v_exp_f32 v33, v33
s_nop 0
v_add_f32 v3, v3, v33
v_cvt_pk_bf16_f32 v33, v33, v33
v_and_b32 v28, v33, v4
v_and_b32 v29, v33, v5
v_and_b32 v30, v33, v6
v_and_b32 v31, v33, v7
s_nop 1
s_waitcnt vmcnt(6)
s_cbranch_vccnz L_fb274
s_waitcnt vmcnt(4)
L_fb274:
buffer_load_dwordx4 v[116:119], v1, s[12:15], s39 offen offset:128 nt
s_memrealtime s[88:89]
ds_read_b64 v[252:253], v21 offset:15904
v_mfma_f32_16x16x32_bf16 v[8:11], v[28:31], v[236:239], v[8:11]
s_waitcnt vmcnt(6)
s_cbranch_vccnz L_fb275
s_waitcnt vmcnt(4)
L_fb275:
buffer_load_dwordx4 v[120:123], v1, s[12:15], s39 offen offset:256 nt
s_waitcnt lgkmcnt(0)
v_mov_b32 v255, 4006
v_mul_u32_u24 v253, v255, v253
v_mov_b32 v254, s88
v_lshrrev_b32 v253, 12, v253
ds_write_b64 v21, v[254:255] offset:15872
v_add_u32 v253, v253, v252
v_sub_u32 v253, v254, v253
v_cmp_lt_i32 vcc, 0, v253
v_mfma_f32_16x16x32_bf16 v[12:15], v[28:31], v[240:243], v[12:15]
s_waitcnt vmcnt(6)
s_cbranch_vccnz L_fb276
s_waitcnt vmcnt(4)
L_fb276:
s_add_u32 s39, s7, 2752512
buffer_load_dwordx4 v[124:127], v1, s[12:15], s39 offen offset:0 nt
v_mfma_f32_16x16x32_bf16 v[16:19], v[28:31], v[244:247], v[16:19]
v_fma_f32 v33, v66, s62, -v2
v_exp_f32 v33, v33
s_nop 0
v_add_f32 v3, v3, v33
v_cvt_pk_bf16_f32 v33, v33, v33
v_and_b32 v28, v33, v4
v_and_b32 v29, v33, v5
v_and_b32 v30, v33, v6
v_and_b32 v31, v33, v7
s_nop 1
s_waitcnt vmcnt(6)
s_cbranch_vccnz L_fb277
s_waitcnt vmcnt(4)
L_fb277:
buffer_load_dwordx4 v[128:131], v1, s[12:15], s39 offen offset:128 nt
v_mfma_f32_16x16x32_bf16 v[8:11], v[28:31], v[248:251], v[8:11]
s_waitcnt vmcnt(6)
s_cbranch_vccnz L_fb278
s_waitcnt vmcnt(4)
L_fb278:
buffer_load_dwordx4 v[132:135], v1, s[12:15], s39 offen offset:256 nt
v_mfma_f32_16x16x32_bf16 v[12:15], v[28:31], v[104:107], v[12:15]
s_waitcnt vmcnt(6)
s_cbranch_vccnz L_fb279
s_waitcnt vmcnt(4)
L_fb279:
s_add_u32 s39, s7, 2850816
buffer_load_dwordx4 v[136:139], v1, s[12:15], s39 offen offset:0 nt
v_mfma_f32_16x16x32_bf16 v[16:19], v[28:31], v[108:111], v[16:19]
v_fma_f32 v33, v67, s62, -v2
v_exp_f32 v33, v33
s_nop 0
v_add_f32 v3, v3, v33
v_cvt_pk_bf16_f32 v33, v33, v33
v_and_b32 v28, v33, v4
v_and_b32 v29, v33, v5
v_and_b32 v30, v33, v6
v_and_b32 v31, v33, v7
s_nop 1
s_waitcnt vmcnt(6)
s_cbranch_vccnz L_fb280
s_waitcnt vmcnt(4)
L_fb280:
buffer_load_dwordx4 v[140:143], v1, s[12:15], s39 offen offset:128 nt
s_memrealtime s[88:89]
ds_read_b64 v[252:253], v21 offset:15904
v_mfma_f32_16x16x32_bf16 v[8:11], v[28:31], v[112:115], v[8:11]
s_waitcnt vmcnt(6)
s_cbranch_vccnz L_fb281
s_waitcnt vmcnt(4)
L_fb281:
buffer_load_dwordx4 v[144:147], v1, s[12:15], s39 offen offset:256 nt
s_waitcnt lgkmcnt(0)
v_mov_b32 v255, 4087
v_mul_u32_u24 v253, v255, v253
v_mov_b32 v254, s88
v_lshrrev_b32 v253, 12, v253
ds_write_b64 v21, v[254:255] offset:15872
v_add_u32 v253, v253, v252
v_sub_u32 v253, v254, v253
v_cmp_lt_i32 vcc, 0, v253
v_mfma_f32_16x16x32_bf16 v[12:15], v[28:31], v[116:119], v[12:15]
s_waitcnt vmcnt(6)
s_cbranch_vccnz L_fb282
s_waitcnt vmcnt(4)
L_fb282:
s_add_u32 s39, s7, 2949120
buffer_load_dwordx4 v[148:151], v1, s[12:15], s39 offen offset:0 nt
v_mfma_f32_16x16x32_bf16 v[16:19], v[28:31], v[120:123], v[16:19]
v_fma_f32 v33, v68, s62, -v2
v_exp_f32 v33, v33
s_nop 0
v_add_f32 v3, v3, v33
v_cvt_pk_bf16_f32 v33, v33, v33
v_and_b32 v28, v33, v4
v_and_b32 v29, v33, v5
v_and_b32 v30, v33, v6
v_and_b32 v31, v33, v7
s_nop 1
s_waitcnt vmcnt(6)
s_cbranch_vccnz L_fb283
s_waitcnt vmcnt(4)
L_fb283:
buffer_load_dwordx4 v[152:155], v1, s[12:15], s39 offen offset:128 nt
v_mfma_f32_16x16x32_bf16 v[8:11], v[28:31], v[124:127], v[8:11]
s_waitcnt vmcnt(6)
s_cbranch_vccnz L_fb284
s_waitcnt vmcnt(4)
L_fb284:
buffer_load_dwordx4 v[156:159], v1, s[12:15], s39 offen offset:256 nt
v_mfma_f32_16x16x32_bf16 v[12:15], v[28:31], v[128:131], v[12:15]
s_waitcnt vmcnt(6)
s_cbranch_vccnz L_fb285
s_waitcnt vmcnt(4)
L_fb285:
s_add_u32 s39, s7, 3047424
buffer_load_dwordx4 v[160:163], v1, s[12:15], s39 offen offset:0 nt
v_mfma_f32_16x16x32_bf16 v[16:19], v[28:31], v[132:135], v[16:19]
v_fma_f32 v33, v69, s62, -v2
v_exp_f32 v33, v33
s_nop 0
v_add_f32 v3, v3, v33
v_cvt_pk_bf16_f32 v33, v33, v33
v_and_b32 v28, v33, v4
v_and_b32 v29, v33, v5
v_and_b32 v30, v33, v6
v_and_b32 v31, v33, v7
s_nop 1
s_waitcnt vmcnt(6)
s_cbranch_vccnz L_fb286
s_waitcnt vmcnt(4)
L_fb286:
buffer_load_dwordx4 v[164:167], v1, s[12:15], s39 offen offset:128 nt
s_memrealtime s[88:89]
ds_read_b64 v[252:253], v21 offset:15904
v_mfma_f32_16x16x32_bf16 v[8:11], v[28:31], v[136:139], v[8:11]
s_waitcnt vmcnt(6)
s_cbranch_vccnz L_fb287
s_waitcnt vmcnt(4)
L_fb287:
buffer_load_dwordx4 v[168:171], v1, s[12:15], s39 offen offset:256 nt
s_waitcnt lgkmcnt(0)
v_mov_b32 v255, 4168
v_mul_u32_u24 v253, v255, v253
v_mov_b32 v254, s88
v_lshrrev_b32 v253, 12, v253
ds_write_b64 v21, v[254:255] offset:15872
v_add_u32 v253, v253, v252
v_sub_u32 v253, v254, v253
v_cmp_lt_i32 vcc, 0, v253
v_mfma_f32_16x16x32_bf16 v[12:15], v[28:31], v[140:143], v[12:15]
s_waitcnt vmcnt(6)
s_cbranch_vccnz L_fb288
s_waitcnt vmcnt(4)
L_fb288:
s_add_u32 s39, s7, 3145728
buffer_load_dwordx4 v[172:175], v1, s[12:15], s39 offen offset:0 nt
v_mfma_f32_16x16x32_bf16 v[16:19], v[28:31], v[144:147], v[16:19]
v_fma_f32 v33, v70, s62, -v2
v_exp_f32 v33, v33
s_nop 0
v_add_f32 v3, v3, v33
v_cvt_pk_bf16_f32 v33, v33, v33
v_and_b32 v28, v33, v4
v_and_b32 v29, v33, v5
v_and_b32 v30, v33, v6
v_and_b32 v31, v33, v7
s_nop 1
s_waitcnt vmcnt(6)
s_cbranch_vccnz L_fb289
s_waitcnt vmcnt(4)
L_fb289:
buffer_load_dwordx4 v[176:179], v1, s[12:15], s39 offen offset:128 nt
v_mfma_f32_16x16x32_bf16 v[8:11], v[28:31], v[148:151], v[8:11]
s_waitcnt vmcnt(6)
s_cbranch_vccnz L_fb290
s_waitcnt vmcnt(4)
L_fb290:
buffer_load_dwordx4 v[180:183], v1, s[12:15], s39 offen offset:256 nt
v_mfma_f32_16x16x32_bf16 v[12:15], v[28:31], v[152:155], v[12:15]
s_waitcnt vmcnt(6)
s_cbranch_vccnz L_fb291
s_waitcnt vmcnt(4)
L_fb291:
s_add_u32 s39, s7, 3244032
buffer_load_dwordx4 v[184:187], v1, s[12:15], s39 offen offset:0 nt
v_mfma_f32_16x16x32_bf16 v[16:19], v[28:31], v[156:159], v[16:19]
v_fma_f32 v33, v71, s62, -v2
v_exp_f32 v33, v33
s_nop 0
v_add_f32 v3, v3, v33
v_cvt_pk_bf16_f32 v33, v33, v33
v_and_b32 v28, v33, v4
v_and_b32 v29, v33, v5
v_and_b32 v30, v33, v6
v_and_b32 v31, v33, v7
s_nop 1
s_waitcnt vmcnt(6)
s_cbranch_vccnz L_fb292
s_waitcnt vmcnt(4)
L_fb292:
buffer_load_dwordx4 v[188:191], v1, s[12:15], s39 offen offset:128 nt
s_memrealtime s[88:89]
ds_read_b64 v[252:253], v21 offset:15904
v_mfma_f32_16x16x32_bf16 v[8:11], v[28:31], v[160:163], v[8:11]
s_waitcnt vmcnt(6)
s_cbranch_vccnz L_fb293
s_waitcnt vmcnt(4)
L_fb293:
buffer_load_dwordx4 v[192:195], v1, s[12:15], s39 offen offset:256 nt
s_waitcnt lgkmcnt(0)
v_mov_b32 v255, 4249
v_mul_u32_u24 v253, v255, v253
v_mov_b32 v254, s88
v_lshrrev_b32 v253, 12, v253
ds_write_b64 v21, v[254:255] offset:15872
v_add_u32 v253, v253, v252
v_sub_u32 v253, v254, v253
v_cmp_lt_i32 vcc, 0, v253
v_mfma_f32_16x16x32_bf16 v[12:15], v[28:31], v[164:167], v[12:15]
s_waitcnt vmcnt(6)
s_cbranch_vccnz L_fb294
s_waitcnt vmcnt(4)
L_fb294:
s_add_u32 s39, s7, 3342336
buffer_load_dwordx4 v[196:199], v1, s[12:15], s39 offen offset:0 nt
v_mfma_f32_16x16x32_bf16 v[16:19], v[28:31], v[168:171], v[16:19]
v_fma_f32 v33, v72, s62, -v2
v_exp_f32 v33, v33
s_nop 0
v_add_f32 v3, v3, v33
v_cvt_pk_bf16_f32 v33, v33, v33
v_and_b32 v28, v33, v4
v_and_b32 v29, v33, v5
v_and_b32 v30, v33, v6
v_and_b32 v31, v33, v7
s_nop 1
s_waitcnt vmcnt(6)
s_cbranch_vccnz L_fb295
s_waitcnt vmcnt(4)
L_fb295:
buffer_load_dwordx4 v[200:203], v1, s[12:15], s39 offen offset:128 nt
v_mfma_f32_16x16x32_bf16 v[8:11], v[28:31], v[172:175], v[8:11]
s_waitcnt vmcnt(6)
s_cbranch_vccnz L_fb296
s_waitcnt vmcnt(4)
L_fb296:
buffer_load_dwordx4 v[204:207], v1, s[12:15], s39 offen offset:256 nt
v_mfma_f32_16x16x32_bf16 v[12:15], v[28:31], v[176:179], v[12:15]
s_waitcnt vmcnt(6)
s_cbranch_vccnz L_fb297
s_waitcnt vmcnt(4)
L_fb297:
s_add_u32 s39, s7, 3440640
buffer_load_dwordx4 v[208:211], v1, s[12:15], s39 offen offset:0 nt
v_mfma_f32_16x16x32_bf16 v[16:19], v[28:31], v[180:183], v[16:19]
v_fma_f32 v33, v73, s62, -v2
v_exp_f32 v33, v33
s_nop 0
v_add_f32 v3, v3, v33
v_cvt_pk_bf16_f32 v33, v33, v33
v_and_b32 v28, v33, v4
v_and_b32 v29, v33, v5
v_and_b32 v30, v33, v6
v_and_b32 v31, v33, v7
s_nop 1
s_waitcnt vmcnt(6)
s_cbranch_vccnz L_fb298
s_waitcnt vmcnt(4)
L_fb298:
buffer_load_dwordx4 v[212:215], v1, s[12:15], s39 offen offset:128 nt
s_memrealtime s[88:89]
ds_read_b64 v[252:253], v21 offset:15904
v_mfma_f32_16x16x32_bf16 v[8:11], v[28:31], v[184:187], v[8:11]
s_waitcnt vmcnt(6)
s_cbranch_vccnz L_fb299
s_waitcnt vmcnt(4)
L_fb299:
buffer_load_dwordx4 v[216:219], v1, s[12:15], s39 offen offset:256 nt
s_waitcnt lgkmcnt(0)
v_mov_b32 v255, 4330
v_mul_u32_u24 v253, v255, v253
v_mov_b32 v254, s88
v_lshrrev_b32 v253, 12, v253
ds_write_b64 v21, v[254:255] offset:15872
v_add_u32 v253, v253, v252
v_sub_u32 v253, v254, v253
v_cmp_lt_i32 vcc, 0, v253
v_mfma_f32_16x16x32_bf16 v[12:15], v[28:31], v[188:191], v[12:15]
s_waitcnt vmcnt(6)
s_cbranch_vccnz L_fb300
s_waitcnt vmcnt(4)
L_fb300:
s_add_u32 s39, s7, 3538944
buffer_load_dwordx4 v[220:223], v1, s[12:15], s39 offen offset:0 nt
v_mfma_f32_16x16x32_bf16 v[16:19], v[28:31], v[192:195], v[16:19]
v_fma_f32 v33, v74, s62, -v2
v_exp_f32 v33, v33
s_nop 0
v_add_f32 v3, v3, v33
v_cvt_pk_bf16_f32 v33, v33, v33
v_and_b32 v28, v33, v4
v_and_b32 v29, v33, v5
v_and_b32 v30, v33, v6
v_and_b32 v31, v33, v7
s_nop 1
s_waitcnt vmcnt(6)
s_cbranch_vccnz L_fb301
s_waitcnt vmcnt(4)
L_fb301:
buffer_load_dwordx4 v[224:227], v1, s[12:15], s39 offen offset:128 nt
v_mfma_f32_16x16x32_bf16 v[8:11], v[28:31], v[196:199], v[8:11]
s_waitcnt vmcnt(6)
s_cbranch_vccnz L_fb302
s_waitcnt vmcnt(4)
L_fb302:
buffer_load_dwordx4 v[228:231], v1, s[12:15], s39 offen offset:256 nt
v_mfma_f32_16x16x32_bf16 v[12:15], v[28:31], v[200:203], v[12:15]
s_waitcnt vmcnt(6)
s_cbranch_vccnz L_fb303
s_waitcnt vmcnt(4)
L_fb303:
s_add_u32 s39, s7, 3637248
buffer_load_dwordx4 v[232:235], v1, s[12:15], s39 offen offset:0 nt
v_mfma_f32_16x16x32_bf16 v[16:19], v[28:31], v[204:207], v[16:19]
v_fma_f32 v33, v75, s62, -v2
v_exp_f32 v33, v33
s_nop 0
v_add_f32 v3, v3, v33
v_cvt_pk_bf16_f32 v33, v33, v33
v_and_b32 v28, v33, v4
v_and_b32 v29, v33, v5
v_and_b32 v30, v33, v6
v_and_b32 v31, v33, v7
s_nop 1
s_waitcnt vmcnt(6)
s_cbranch_vccnz L_fb304
s_waitcnt vmcnt(4)
L_fb304:
buffer_load_dwordx4 v[236:239], v1, s[12:15], s39 offen offset:128 nt
s_memrealtime s[88:89]
ds_read_b64 v[252:253], v21 offset:15904
v_mfma_f32_16x16x32_bf16 v[8:11], v[28:31], v[208:211], v[8:11]
s_waitcnt vmcnt(6)
s_cbranch_vccnz L_fb305
s_waitcnt vmcnt(4)
L_fb305:
buffer_load_dwordx4 v[240:243], v1, s[12:15], s39 offen offset:256 nt
s_waitcnt lgkmcnt(0)
v_mov_b32 v255, 4411
v_mul_u32_u24 v253, v255, v253
v_mov_b32 v254, s88
v_lshrrev_b32 v253, 12, v253
ds_write_b64 v21, v[254:255] offset:15872
v_add_u32 v253, v253, v252
v_sub_u32 v253, v254, v253
v_cmp_lt_i32 vcc, 0, v253
v_mfma_f32_16x16x32_bf16 v[12:15], v[28:31], v[212:215], v[12:15]
s_waitcnt vmcnt(6)
s_cbranch_vccnz L_fb306
s_waitcnt vmcnt(4)
L_fb306:
s_add_u32 s39, s7, 3735552
buffer_load_dwordx4 v[244:247], v1, s[12:15], s39 offen offset:0 nt
v_mfma_f32_16x16x32_bf16 v[16:19], v[28:31], v[216:219], v[16:19]
v_fma_f32 v33, v76, s62, -v2
v_exp_f32 v33, v33
s_nop 0
v_add_f32 v3, v3, v33
v_cvt_pk_bf16_f32 v33, v33, v33
v_and_b32 v28, v33, v4
v_and_b32 v29, v33, v5
v_and_b32 v30, v33, v6
v_and_b32 v31, v33, v7
s_nop 1
s_waitcnt vmcnt(6)
s_cbranch_vccnz L_fb307
s_waitcnt vmcnt(4)
L_fb307:
buffer_load_dwordx4 v[248:251], v1, s[12:15], s39 offen offset:128 nt
v_mfma_f32_16x16x32_bf16 v[8:11], v[28:31], v[220:223], v[8:11]
s_waitcnt vmcnt(6)
s_cbranch_vccnz L_fb308
s_waitcnt vmcnt(4)
L_fb308:
buffer_load_dwordx4 v[104:107], v1, s[12:15], s39 offen offset:256 nt
v_mfma_f32_16x16x32_bf16 v[12:15], v[28:31], v[224:227], v[12:15]
s_waitcnt vmcnt(6)
s_cbranch_vccnz L_fb309
s_waitcnt vmcnt(4)
L_fb309:
s_add_u32 s39, s7, 3833856
buffer_load_dwordx4 v[108:111], v1, s[12:15], s39 offen offset:0 nt
v_mfma_f32_16x16x32_bf16 v[16:19], v[28:31], v[228:231], v[16:19]
v_fma_f32 v33, v77, s62, -v2
v_exp_f32 v33, v33
s_nop 0
v_add_f32 v3, v3, v33
v_cvt_pk_bf16_f32 v33, v33, v33
v_and_b32 v28, v33, v4
v_and_b32 v29, v33, v5
v_and_b32 v30, v33, v6
v_and_b32 v31, v33, v7
s_nop 1
s_waitcnt vmcnt(6)
s_cbranch_vccnz L_fb310
s_waitcnt vmcnt(4)
L_fb310:
buffer_load_dwordx4 v[112:115], v1, s[12:15], s39 offen offset:128 nt
s_memrealtime s[88:89]
ds_read_b64 v[252:253], v21 offset:15904
v_mfma_f32_16x16x32_bf16 v[8:11], v[28:31], v[232:235], v[8:11]
s_waitcnt vmcnt(6)
s_cbranch_vccnz L_fb311
s_waitcnt vmcnt(4)
L_fb311:
buffer_load_dwordx4 v[116:119], v1, s[12:15], s39 offen offset:256 nt
s_waitcnt lgkmcnt(0)
v_mov_b32 v255, 4492
v_mul_u32_u24 v253, v255, v253
v_mov_b32 v254, s88
v_lshrrev_b32 v253, 12, v253
ds_write_b64 v21, v[254:255] offset:15872
v_add_u32 v253, v253, v252
v_sub_u32 v253, v254, v253
v_cmp_lt_i32 vcc, 0, v253
v_mfma_f32_16x16x32_bf16 v[12:15], v[28:31], v[236:239], v[12:15]
s_waitcnt vmcnt(6)
s_cbranch_vccnz L_fb312
s_waitcnt vmcnt(4)
L_fb312:
s_add_u32 s39, s7, 3932160
buffer_load_dwordx4 v[120:123], v1, s[12:15], s39 offen offset:0 nt
v_mfma_f32_16x16x32_bf16 v[16:19], v[28:31], v[240:243], v[16:19]
v_fma_f32 v33, v78, s62, -v2
v_exp_f32 v33, v33
s_nop 0
v_add_f32 v3, v3, v33
v_cvt_pk_bf16_f32 v33, v33, v33
v_and_b32 v28, v33, v4
v_and_b32 v29, v33, v5
v_and_b32 v30, v33, v6
v_and_b32 v31, v33, v7
s_nop 1
s_waitcnt vmcnt(6)
s_cbranch_vccnz L_fb313
s_waitcnt vmcnt(4)
L_fb313:
buffer_load_dwordx4 v[124:127], v1, s[12:15], s39 offen offset:128 nt
v_mfma_f32_16x16x32_bf16 v[8:11], v[28:31], v[244:247], v[8:11]
s_waitcnt vmcnt(6)
s_cbranch_vccnz L_fb314
s_waitcnt vmcnt(4)
L_fb314:
buffer_load_dwordx4 v[128:131], v1, s[12:15], s39 offen offset:256 nt
v_mfma_f32_16x16x32_bf16 v[12:15], v[28:31], v[248:251], v[12:15]
s_waitcnt vmcnt(6)
s_cbranch_vccnz L_fb315
s_waitcnt vmcnt(4)
L_fb315:
s_add_u32 s39, s7, 4030464
buffer_load_dwordx4 v[132:135], v1, s[12:15], s39 offen offset:0 nt
v_mfma_f32_16x16x32_bf16 v[16:19], v[28:31], v[104:107], v[16:19]
v_fma_f32 v33, v79, s62, -v2
v_exp_f32 v33, v33
s_nop 0
v_add_f32 v3, v3, v33
v_cvt_pk_bf16_f32 v33, v33, v33
v_and_b32 v28, v33, v4
v_and_b32 v29, v33, v5
v_and_b32 v30, v33, v6
v_and_b32 v31, v33, v7
s_nop 1
s_waitcnt vmcnt(6)
s_cbranch_vccnz L_fb316
s_waitcnt vmcnt(4)
L_fb316:
buffer_load_dwordx4 v[136:139], v1, s[12:15], s39 offen offset:128 nt
s_memrealtime s[88:89]
ds_read_b64 v[252:253], v21 offset:15904
v_mfma_f32_16x16x32_bf16 v[8:11], v[28:31], v[108:111], v[8:11]
s_waitcnt vmcnt(6)
s_cbranch_vccnz L_fb317
s_waitcnt vmcnt(4)
L_fb317:
buffer_load_dwordx4 v[140:143], v1, s[12:15], s39 offen offset:256 nt
s_waitcnt lgkmcnt(0)
v_mov_b32 v255, 4573
v_mul_u32_u24 v253, v255, v253
v_mov_b32 v254, s88
v_lshrrev_b32 v253, 12, v253
ds_write_b64 v21, v[254:255] offset:15872
v_add_u32 v253, v253, v252
v_sub_u32 v253, v254, v253
v_cmp_lt_i32 vcc, 0, v253
v_mfma_f32_16x16x32_bf16 v[12:15], v[28:31], v[112:115], v[12:15]
s_waitcnt vmcnt(6)
s_cbranch_vccnz L_fb318
s_waitcnt vmcnt(4)
L_fb318:
s_add_u32 s39, s7, 4128768
buffer_load_dwordx4 v[144:147], v1, s[12:15], s39 offen offset:0 nt
v_mfma_f32_16x16x32_bf16 v[16:19], v[28:31], v[116:119], v[16:19]
v_fma_f32 v33, v80, s62, -v2
v_exp_f32 v33, v33
s_nop 0
v_add_f32 v3, v3, v33
v_cvt_pk_bf16_f32 v33, v33, v33
v_and_b32 v28, v33, v4
v_and_b32 v29, v33, v5
v_and_b32 v30, v33, v6
v_and_b32 v31, v33, v7
s_nop 1
s_waitcnt vmcnt(6)
s_cbranch_vccnz L_fb319
s_waitcnt vmcnt(4)
L_fb319:
buffer_load_dwordx4 v[148:151], v1, s[12:15], s39 offen offset:128 nt
v_mfma_f32_16x16x32_bf16 v[8:11], v[28:31], v[120:123], v[8:11]
s_waitcnt vmcnt(6)
s_cbranch_vccnz L_fb320
s_waitcnt vmcnt(4)
L_fb320:
buffer_load_dwordx4 v[152:155], v1, s[12:15], s39 offen offset:256 nt
v_mfma_f32_16x16x32_bf16 v[12:15], v[28:31], v[124:127], v[12:15]
s_waitcnt vmcnt(6)
s_cbranch_vccnz L_fb321
s_waitcnt vmcnt(4)
L_fb321:
s_add_u32 s39, s7, 4227072
buffer_load_dwordx4 v[156:159], v1, s[12:15], s39 offen offset:0 nt
v_mfma_f32_16x16x32_bf16 v[16:19], v[28:31], v[128:131], v[16:19]
v_fma_f32 v33, v81, s62, -v2
v_exp_f32 v33, v33
s_nop 0
v_add_f32 v3, v3, v33
v_cvt_pk_bf16_f32 v33, v33, v33
v_and_b32 v28, v33, v4
v_and_b32 v29, v33, v5
v_and_b32 v30, v33, v6
v_and_b32 v31, v33, v7
s_nop 1
s_waitcnt vmcnt(6)
s_cbranch_vccnz L_fb322
s_waitcnt vmcnt(4)
L_fb322:
buffer_load_dwordx4 v[160:163], v1, s[12:15], s39 offen offset:128 nt
s_memrealtime s[88:89]
ds_read_b64 v[252:253], v21 offset:15904
v_mfma_f32_16x16x32_bf16 v[8:11], v[28:31], v[132:135], v[8:11]
s_waitcnt vmcnt(6)
s_cbranch_vccnz L_fb323
s_waitcnt vmcnt(4)
L_fb323:
buffer_load_dwordx4 v[164:167], v1, s[12:15], s39 offen offset:256 nt
s_waitcnt lgkmcnt(0)
v_mov_b32 v255, 4654
v_mul_u32_u24 v253, v255, v253
v_mov_b32 v254, s88
v_lshrrev_b32 v253, 12, v253
ds_write_b64 v21, v[254:255] offset:15872
v_add_u32 v253, v253, v252
v_sub_u32 v253, v254, v253
v_cmp_lt_i32 vcc, 0, v253
v_mfma_f32_16x16x32_bf16 v[12:15], v[28:31], v[136:139], v[12:15]
s_waitcnt vmcnt(6)
s_cbranch_vccnz L_fb324
s_waitcnt vmcnt(4)
L_fb324:
buffer_load_dwordx4 v[168:171], v34, s[20:23], s56 offen offset:0 nt
v_mfma_f32_16x16x32_bf16 v[16:19], v[28:31], v[140:143], v[16:19]
v_fma_f32 v33, v82, s62, -v2
v_exp_f32 v33, v33
s_nop 0
v_add_f32 v3, v3, v33
v_cvt_pk_bf16_f32 v33, v33, v33
v_and_b32 v28, v33, v4
v_and_b32 v29, v33, v5
v_and_b32 v30, v33, v6
v_and_b32 v31, v33, v7
s_nop 1
s_waitcnt vmcnt(6)
s_cbranch_vccnz L_fb325
s_waitcnt vmcnt(4)
L_fb325:
buffer_load_dwordx4 v[172:175], v34, s[20:23], s56 offen offset:512 nt
v_mfma_f32_16x16x32_bf16 v[8:11], v[28:31], v[144:147], v[8:11]
s_waitcnt vmcnt(6)
s_cbranch_vccnz L_fb326
s_waitcnt vmcnt(4)
L_fb326:
buffer_load_dwordx4 v[176:179], v35, s[20:23], s56 offen offset:1024 nt
v_mfma_f32_16x16x32_bf16 v[12:15], v[28:31], v[148:151], v[12:15]
s_waitcnt vmcnt(6)
s_cbranch_vccnz L_fb327
s_waitcnt vmcnt(4)
L_fb327:
buffer_load_dwordx4 v[180:183], v34, s[20:23], s57 offen offset:0 nt
v_mfma_f32_16x16x32_bf16 v[16:19], v[28:31], v[152:155], v[16:19]
v_fma_f32 v33, v83, s62, -v2
v_exp_f32 v33, v33
s_nop 0
v_add_f32 v3, v3, v33
v_cvt_pk_bf16_f32 v33, v33, v33
v_and_b32 v28, v33, v4
v_and_b32 v29, v33, v5
v_and_b32 v30, v33, v6
v_and_b32 v31, v33, v7
s_nop 1
s_waitcnt vmcnt(6)
s_cbranch_vccnz L_fb328
s_waitcnt vmcnt(4)
L_fb328:
buffer_load_dwordx4 v[184:187], v34, s[20:23], s57 offen offset:512 nt
s_memrealtime s[88:89]
ds_read_b64 v[252:253], v21 offset:15904
v_mfma_f32_16x16x32_bf16 v[8:11], v[28:31], v[156:159], v[8:11]
s_waitcnt vmcnt(6)
s_cbranch_vccnz L_fb329
s_waitcnt vmcnt(4)
L_fb329:
buffer_load_dwordx4 v[188:191], v35, s[20:23], s57 offen offset:1024 nt
s_waitcnt lgkmcnt(0)
v_mov_b32 v255, 4735
v_mul_u32_u24 v253, v255, v253
v_mov_b32 v254, s88
v_lshrrev_b32 v253, 12, v253
ds_write_b64 v21, v[254:255] offset:15872
v_add_u32 v253, v253, v252
v_sub_u32 v253, v254, v253
v_cmp_lt_i32 vcc, 0, v253
v_mfma_f32_16x16x32_bf16 v[12:15], v[28:31], v[160:163], v[12:15]
s_waitcnt vmcnt(6)
s_cbranch_vccnz L_fb330
s_waitcnt vmcnt(4)
L_fb330:
buffer_load_dwordx4 v[192:195], v34, s[20:23], s58 offen offset:0 nt
v_mfma_f32_16x16x32_bf16 v[16:19], v[28:31], v[164:167], v[16:19]
v_fma_f32 v33, v84, s62, -v2
v_exp_f32 v33, v33
s_nop 0
v_add_f32 v3, v3, v33
v_cvt_pk_bf16_f32 v33, v33, v33
v_and_b32 v28, v33, v4
v_and_b32 v29, v33, v5
v_and_b32 v30, v33, v6
v_and_b32 v31, v33, v7
s_nop 1
s_waitcnt vmcnt(6)
s_cbranch_vccnz L_fb331
s_waitcnt vmcnt(4)
L_fb331:
buffer_load_dwordx4 v[196:199], v34, s[20:23], s58 offen offset:512 nt
s_waitcnt vmcnt(6)
s_cbranch_vccnz L_fb332
s_waitcnt vmcnt(4)
L_fb332:
buffer_load_dwordx4 v[200:203], v35, s[20:23], s58 offen offset:1024 nt
s_waitcnt vmcnt(6)
s_cbranch_vccnz L_fb333
s_waitcnt vmcnt(4)
L_fb333:
s_add_u32 s39, s7, 4325376
buffer_load_dwordx4 v[204:207], v1, s[12:15], s39 offen offset:0 nt
s_waitcnt vmcnt(6)
s_cbranch_vccnz L_fb334
s_waitcnt vmcnt(4)
L_fb334:
buffer_load_dwordx4 v[208:211], v1, s[12:15], s39 offen offset:128 nt
s_memrealtime s[88:89]
ds_read_b64 v[252:253], v21 offset:15904
s_waitcnt vmcnt(6)
s_cbranch_vccnz L_fb335
s_waitcnt vmcnt(4)
L_fb335:
buffer_load_dwordx4 v[212:215], v1, s[12:15], s39 offen offset:256 nt
s_waitcnt lgkmcnt(0)
v_mov_b32 v255, 4816
v_mul_u32_u24 v253, v255, v253
v_mov_b32 v254, s88
v_lshrrev_b32 v253, 12, v253
ds_write_b64 v21, v[254:255] offset:15872
v_add_u32 v253, v253, v252
v_sub_u32 v253, v254, v253
v_cmp_lt_i32 vcc, 0, v253
s_waitcnt vmcnt(6)
s_cbranch_vccnz L_fb336
s_waitcnt vmcnt(4)
L_fb336:
s_add_u32 s39, s7, 4423680
buffer_load_dwordx4 v[216:219], v1, s[12:15], s39 offen offset:0 nt
s_waitcnt vmcnt(6)
s_cbranch_vccnz L_fb337
s_waitcnt vmcnt(4)
L_fb337:
buffer_load_dwordx4 v[220:223], v1, s[12:15], s39 offen offset:128 nt
s_waitcnt vmcnt(6)
s_cbranch_vccnz L_fb338
s_waitcnt vmcnt(4)
L_fb338:
buffer_load_dwordx4 v[224:227], v1, s[12:15], s39 offen offset:256 nt
s_waitcnt vmcnt(6)
s_cbranch_vccnz L_fb339
s_waitcnt vmcnt(4)
L_fb339:
s_add_u32 s39, s7, 4521984
buffer_load_dwordx4 v[228:231], v1, s[12:15], s39 offen offset:0 nt
s_waitcnt vmcnt(6)
s_cbranch_vccnz L_fb340
s_waitcnt vmcnt(4)
L_fb340:
buffer_load_dwordx4 v[232:235], v1, s[12:15], s39 offen offset:128 nt
s_memrealtime s[88:89]
ds_read_b64 v[252:253], v21 offset:15904
v_mfma_f32_16x16x32_bf16 v[8:11], v[28:31], v[204:207], v[8:11]
s_waitcnt vmcnt(6)
s_cbranch_vccnz L_fb341
s_waitcnt vmcnt(4)
L_fb341:
buffer_load_dwordx4 v[236:239], v1, s[12:15], s39 offen offset:256 nt
s_waitcnt lgkmcnt(0)
v_mov_b32 v255, 4897
v_mul_u32_u24 v253, v255, v253
v_mov_b32 v254, s88
v_lshrrev_b32 v253, 12, v253
ds_write_b64 v21, v[254:255] offset:15872
v_add_u32 v253, v253, v252
v_sub_u32 v253, v254, v253
v_cmp_lt_i32 vcc, 0, v253
v_mfma_f32_16x16x32_bf16 v[12:15], v[28:31], v[208:211], v[12:15]
s_waitcnt vmcnt(6)
s_cbranch_vccnz L_fb342
s_waitcnt vmcnt(4)
L_fb342:
s_add_u32 s39, s7, 4620288
buffer_load_dwordx4 v[240:243], v1, s[12:15], s39 offen offset:0 nt
v_mfma_f32_16x16x32_bf16 v[16:19], v[28:31], v[212:215], v[16:19]
v_fma_f32 v33, v85, s62, -v2
v_exp_f32 v33, v33
s_nop 0
v_add_f32 v3, v3, v33
v_cvt_pk_bf16_f32 v33, v33, v33
v_and_b32 v28, v33, v4
v_and_b32 v29, v33, v5
v_and_b32 v30, v33, v6
v_and_b32 v31, v33, v7
s_nop 1
s_waitcnt vmcnt(6)
s_cbranch_vccnz L_fb343
s_waitcnt vmcnt(4)
L_fb343:
buffer_load_dwordx4 v[244:247], v1, s[12:15], s39 offen offset:128 nt
v_mfma_f32_16x16x32_bf16 v[8:11], v[28:31], v[216:219], v[8:11]
s_waitcnt vmcnt(6)
s_cbranch_vccnz L_fb344
s_waitcnt vmcnt(4)
L_fb344:
buffer_load_dwordx4 v[248:251], v1, s[12:15], s39 offen offset:256 nt
v_mfma_f32_16x16x32_bf16 v[12:15], v[28:31], v[220:223], v[12:15]
s_waitcnt vmcnt(6)
s_cbranch_vccnz L_fb345
s_waitcnt vmcnt(4)
L_fb345:
s_add_u32 s39, s7, 4718592
buffer_load_dwordx4 v[104:107], v1, s[12:15], s39 offen offset:0 nt
v_mfma_f32_16x16x32_bf16 v[16:19], v[28:31], v[224:227], v[16:19]
v_fma_f32 v33, v86, s62, -v2
v_exp_f32 v33, v33
s_nop 0
v_add_f32 v3, v3, v33
v_cvt_pk_bf16_f32 v33, v33, v33
v_and_b32 v28, v33, v4
v_and_b32 v29, v33, v5
v_and_b32 v30, v33, v6
v_and_b32 v31, v33, v7
s_nop 1
s_waitcnt vmcnt(6)
s_cbranch_vccnz L_fb346
s_waitcnt vmcnt(4)
L_fb346:
buffer_load_dwordx4 v[108:111], v1, s[12:15], s39 offen offset:128 nt
s_memrealtime s[88:89]
ds_read_b64 v[252:253], v21 offset:15904
v_mfma_f32_16x16x32_bf16 v[8:11], v[28:31], v[228:231], v[8:11]
s_waitcnt vmcnt(6)
s_cbranch_vccnz L_fb347
s_waitcnt vmcnt(4)
L_fb347:
buffer_load_dwordx4 v[112:115], v1, s[12:15], s39 offen offset:256 nt
s_waitcnt lgkmcnt(0)
v_mov_b32 v255, 4979
v_mul_u32_u24 v253, v255, v253
v_mov_b32 v254, s88
v_lshrrev_b32 v253, 12, v253
ds_write_b64 v21, v[254:255] offset:15872
v_add_u32 v253, v253, v252
v_sub_u32 v253, v254, v253
v_cmp_lt_i32 vcc, 0, v253
v_mfma_f32_16x16x32_bf16 v[12:15], v[28:31], v[232:235], v[12:15]
s_waitcnt vmcnt(6)
s_cbranch_vccnz L_fb348
s_waitcnt vmcnt(4)
L_fb348:
s_add_u32 s39, s7, 4816896
buffer_load_dwordx4 v[116:119], v1, s[12:15], s39 offen offset:0 nt
v_mfma_f32_16x16x32_bf16 v[16:19], v[28:31], v[236:239], v[16:19]
v_fma_f32 v33, v87, s62, -v2
v_exp_f32 v33, v33
s_nop 0
v_add_f32 v3, v3, v33
v_cvt_pk_bf16_f32 v33, v33, v33
v_and_b32 v28, v33, v4
v_and_b32 v29, v33, v5
v_and_b32 v30, v33, v6
v_and_b32 v31, v33, v7
s_nop 1
s_waitcnt vmcnt(6)
s_cbranch_vccnz L_fb349
s_waitcnt vmcnt(4)
L_fb349:
buffer_load_dwordx4 v[120:123], v1, s[12:15], s39 offen offset:128 nt
v_mfma_f32_16x16x32_bf16 v[8:11], v[28:31], v[240:243], v[8:11]
s_waitcnt vmcnt(6)
s_cbranch_vccnz L_fb350
s_waitcnt vmcnt(4)
L_fb350:
buffer_load_dwordx4 v[124:127], v1, s[12:15], s39 offen offset:256 nt
v_mfma_f32_16x16x32_bf16 v[12:15], v[28:31], v[244:247], v[12:15]
s_waitcnt vmcnt(6)
s_cbranch_vccnz L_fb351
s_waitcnt vmcnt(4)
L_fb351:
s_add_u32 s39, s7, 4915200
buffer_load_dwordx4 v[128:131], v1, s[12:15], s39 offen offset:0 nt
v_mfma_f32_16x16x32_bf16 v[16:19], v[28:31], v[248:251], v[16:19]
v_fma_f32 v33, v88, s62, -v2
v_exp_f32 v33, v33
s_nop 0
v_add_f32 v3, v3, v33
v_cvt_pk_bf16_f32 v33, v33, v33
v_and_b32 v28, v33, v4
v_and_b32 v29, v33, v5
v_and_b32 v30, v33, v6
v_and_b32 v31, v33, v7
s_nop 1
s_waitcnt vmcnt(6)
s_cbranch_vccnz L_fb352
s_waitcnt vmcnt(4)
L_fb352:
buffer_load_dwordx4 v[132:135], v1, s[12:15], s39 offen offset:128 nt
s_memrealtime s[88:89]
ds_read_b64 v[252:253], v21 offset:15904
v_mfma_f32_16x16x32_bf16 v[8:11], v[28:31], v[104:107], v[8:11]
s_waitcnt vmcnt(6)
s_cbranch_vccnz L_fb353
s_waitcnt vmcnt(4)
L_fb353:
buffer_load_dwordx4 v[136:139], v1, s[12:15], s39 offen offset:256 nt
s_waitcnt lgkmcnt(0)
v_mov_b32 v255, 5060
v_mul_u32_u24 v253, v255, v253
v_mov_b32 v254, s88
v_lshrrev_b32 v253, 12, v253
ds_write_b64 v21, v[254:255] offset:15872
v_add_u32 v253, v253, v252
v_sub_u32 v253, v254, v253
v_cmp_lt_i32 vcc, 0, v253
v_mfma_f32_16x16x32_bf16 v[12:15], v[28:31], v[108:111], v[12:15]
s_waitcnt vmcnt(6)
s_cbranch_vccnz L_fb354
s_waitcnt vmcnt(4)
L_fb354:
s_add_u32 s39, s7, 5013504
buffer_load_dwordx4 v[140:143], v1, s[12:15], s39 offen offset:0 nt
v_mfma_f32_16x16x32_bf16 v[16:19], v[28:31], v[112:115], v[16:19]
v_fma_f32 v33, v89, s62, -v2
v_exp_f32 v33, v33
s_nop 0
v_add_f32 v3, v3, v33
v_cvt_pk_bf16_f32 v33, v33, v33
v_and_b32 v28, v33, v4
v_and_b32 v29, v33, v5
v_and_b32 v30, v33, v6
v_and_b32 v31, v33, v7
s_nop 1
s_waitcnt vmcnt(6)
s_cbranch_vccnz L_fb355
s_waitcnt vmcnt(4)
L_fb355:
buffer_load_dwordx4 v[144:147], v1, s[12:15], s39 offen offset:128 nt
v_mfma_f32_16x16x32_bf16 v[8:11], v[28:31], v[116:119], v[8:11]
s_waitcnt vmcnt(6)
s_cbranch_vccnz L_fb356
s_waitcnt vmcnt(4)
L_fb356:
buffer_load_dwordx4 v[148:151], v1, s[12:15], s39 offen offset:256 nt
v_mfma_f32_16x16x32_bf16 v[12:15], v[28:31], v[120:123], v[12:15]
s_waitcnt vmcnt(6)
s_cbranch_vccnz L_fb357
s_waitcnt vmcnt(4)
L_fb357:
s_add_u32 s39, s7, 5111808
buffer_load_dwordx4 v[152:155], v1, s[12:15], s39 offen offset:0 nt
v_mfma_f32_16x16x32_bf16 v[16:19], v[28:31], v[124:127], v[16:19]
v_fma_f32 v33, v90, s62, -v2
v_exp_f32 v33, v33
s_nop 0
v_add_f32 v3, v3, v33
v_cvt_pk_bf16_f32 v33, v33, v33
v_and_b32 v28, v33, v4
v_and_b32 v29, v33, v5
v_and_b32 v30, v33, v6
v_and_b32 v31, v33, v7
s_nop 1
s_waitcnt vmcnt(6)
s_cbranch_vccnz L_fb358
s_waitcnt vmcnt(4)
L_fb358:
buffer_load_dwordx4 v[156:159], v1, s[12:15], s39 offen offset:128 nt
s_memrealtime s[88:89]
ds_read_b64 v[252:253], v21 offset:15904
v_mfma_f32_16x16x32_bf16 v[8:11], v[28:31], v[128:131], v[8:11]
s_waitcnt vmcnt(6)
s_cbranch_vccnz L_fb359
s_waitcnt vmcnt(4)
L_fb359:
buffer_load_dwordx4 v[160:163], v1, s[12:15], s39 offen offset:256 nt
s_waitcnt lgkmcnt(0)
v_mov_b32 v255, 5141
v_mul_u32_u24 v253, v255, v253
v_mov_b32 v254, s88
v_lshrrev_b32 v253, 12, v253
ds_write_b64 v21, v[254:255] offset:15872
v_add_u32 v253, v253, v252
v_sub_u32 v253, v254, v253
v_cmp_lt_i32 vcc, 0, v253
v_mfma_f32_16x16x32_bf16 v[12:15], v[28:31], v[132:135], v[12:15]
s_waitcnt vmcnt(6)
s_cbranch_vccnz L_fb360
s_waitcnt vmcnt(4)
L_fb360:
s_add_u32 s39, s7, 5210112
buffer_load_dwordx4 v[164:167], v1, s[12:15], s39 offen offset:0 nt
v_mfma_f32_16x16x32_bf16 v[16:19], v[28:31], v[136:139], v[16:19]
v_fma_f32 v33, v91, s62, -v2
v_exp_f32 v33, v33
s_nop 0
v_add_f32 v3, v3, v33
v_cvt_pk_bf16_f32 v33, v33, v33
v_and_b32 v28, v33, v4
v_and_b32 v29, v33, v5
v_and_b32 v30, v33, v6
v_and_b32 v31, v33, v7
s_nop 1
s_waitcnt vmcnt(6)
s_cbranch_vccnz L_fb361
s_waitcnt vmcnt(4)
L_fb361:
buffer_load_dwordx4 v[204:207], v1, s[12:15], s39 offen offset:128 nt
v_mfma_f32_16x16x32_bf16 v[8:11], v[28:31], v[140:143], v[8:11]
s_waitcnt vmcnt(6)
s_cbranch_vccnz L_fb362
s_waitcnt vmcnt(4)
L_fb362:
buffer_load_dwordx4 v[208:211], v1, s[12:15], s39 offen offset:256 nt
v_mfma_f32_16x16x32_bf16 v[12:15], v[28:31], v[144:147], v[12:15]
s_waitcnt vmcnt(6)
s_cbranch_vccnz L_fb363
s_waitcnt vmcnt(4)
L_fb363:
s_add_u32 s39, s7, 5308416
buffer_load_dwordx4 v[212:215], v1, s[12:15], s39 offen offset:0 nt
v_mfma_f32_16x16x32_bf16 v[16:19], v[28:31], v[148:151], v[16:19]
v_fma_f32 v33, v92, s62, -v2
v_exp_f32 v33, v33
s_nop 0
v_add_f32 v3, v3, v33
v_cvt_pk_bf16_f32 v33, v33, v33
v_and_b32 v28, v33, v4
v_and_b32 v29, v33, v5
v_and_b32 v30, v33, v6
v_and_b32 v31, v33, v7
s_nop 1
s_waitcnt vmcnt(6)
s_cbranch_vccnz L_fb364
s_waitcnt vmcnt(4)
L_fb364:
buffer_load_dwordx4 v[216:219], v1, s[12:15], s39 offen offset:128 nt
s_memrealtime s[88:89]
ds_read_b64 v[252:253], v21 offset:15904
v_mfma_f32_16x16x32_bf16 v[8:11], v[28:31], v[152:155], v[8:11]
s_waitcnt vmcnt(6)
s_cbranch_vccnz L_fb365
s_waitcnt vmcnt(4)
L_fb365:
buffer_load_dwordx4 v[220:223], v1, s[12:15], s39 offen offset:256 nt
s_waitcnt lgkmcnt(0)
v_mov_b32 v255, 5222
v_mul_u32_u24 v253, v255, v253
v_mov_b32 v254, s88
v_lshrrev_b32 v253, 12, v253
ds_write_b64 v21, v[254:255] offset:15872
v_add_u32 v253, v253, v252
v_sub_u32 v253, v254, v253
v_cmp_lt_i32 vcc, 0, v253
v_mfma_f32_16x16x32_bf16 v[12:15], v[28:31], v[156:159], v[12:15]
s_waitcnt vmcnt(6)
s_cbranch_vccnz L_fb366
s_waitcnt vmcnt(4)
L_fb366:
s_add_u32 s39, s7, 5406720
buffer_load_dwordx4 v[224:227], v1, s[12:15], s39 offen offset:0 nt
v_mfma_f32_16x16x32_bf16 v[16:19], v[28:31], v[160:163], v[16:19]
v_fma_f32 v33, v93, s62, -v2
v_exp_f32 v33, v33
s_nop 0
v_add_f32 v3, v3, v33
v_cvt_pk_bf16_f32 v33, v33, v33
v_and_b32 v28, v33, v4
v_and_b32 v29, v33, v5
v_and_b32 v30, v33, v6
v_and_b32 v31, v33, v7
s_nop 1
s_waitcnt vmcnt(6)
s_cbranch_vccnz L_fb367
s_waitcnt vmcnt(4)
L_fb367:
buffer_load_dwordx4 v[228:231], v1, s[12:15], s39 offen offset:128 nt
v_mfma_f32_16x16x32_bf16 v[8:11], v[28:31], v[164:167], v[8:11]
s_waitcnt vmcnt(6)
s_cbranch_vccnz L_fb368
s_waitcnt vmcnt(4)
L_fb368:
buffer_load_dwordx4 v[232:235], v1, s[12:15], s39 offen offset:256 nt
v_mfma_f32_16x16x32_bf16 v[12:15], v[28:31], v[204:207], v[12:15]
s_waitcnt vmcnt(6)
s_cbranch_vccnz L_fb369
s_waitcnt vmcnt(4)
L_fb369:
s_add_u32 s39, s7, 5505024
buffer_load_dwordx4 v[236:239], v1, s[12:15], s39 offen offset:0 nt
v_mfma_f32_16x16x32_bf16 v[16:19], v[28:31], v[208:211], v[16:19]
v_fma_f32 v33, v94, s62, -v2
v_exp_f32 v33, v33
s_nop 0
v_add_f32 v3, v3, v33
v_cvt_pk_bf16_f32 v33, v33, v33
v_and_b32 v28, v33, v4
v_and_b32 v29, v33, v5
v_and_b32 v30, v33, v6
v_and_b32 v31, v33, v7
s_nop 1
s_waitcnt vmcnt(6)
s_cbranch_vccnz L_fb370
s_waitcnt vmcnt(4)
L_fb370:
buffer_load_dwordx4 v[240:243], v1, s[12:15], s39 offen offset:128 nt
s_memrealtime s[88:89]
ds_read_b64 v[252:253], v21 offset:15904
v_mfma_f32_16x16x32_bf16 v[8:11], v[28:31], v[212:215], v[8:11]
s_waitcnt vmcnt(6)
s_cbranch_vccnz L_fb371
s_waitcnt vmcnt(4)
L_fb371:
buffer_load_dwordx4 v[244:247], v1, s[12:15], s39 offen offset:256 nt
s_waitcnt lgkmcnt(0)
v_mov_b32 v255, 5303
v_mul_u32_u24 v253, v255, v253
v_mov_b32 v254, s88
v_lshrrev_b32 v253, 12, v253
ds_write_b64 v21, v[254:255] offset:15872
v_add_u32 v253, v253, v252
v_sub_u32 v253, v254, v253
v_cmp_lt_i32 vcc, 0, v253
v_mfma_f32_16x16x32_bf16 v[12:15], v[28:31], v[216:219], v[12:15]
s_waitcnt vmcnt(6)
s_cbranch_vccnz L_fb372
s_waitcnt vmcnt(4)
L_fb372:
s_add_u32 s39, s7, 5603328
buffer_load_dwordx4 v[248:251], v1, s[12:15], s39 offen offset:0 nt
v_mfma_f32_16x16x32_bf16 v[16:19], v[28:31], v[220:223], v[16:19]
v_fma_f32 v33, v95, s62, -v2
v_exp_f32 v33, v33
s_nop 0
v_add_f32 v3, v3, v33
v_cvt_pk_bf16_f32 v33, v33, v33
v_and_b32 v28, v33, v4
v_and_b32 v29, v33, v5
v_and_b32 v30, v33, v6
v_and_b32 v31, v33, v7
s_nop 1
s_waitcnt vmcnt(6)
s_cbranch_vccnz L_fb373
s_waitcnt vmcnt(4)
L_fb373:
buffer_load_dwordx4 v[104:107], v1, s[12:15], s39 offen offset:128 nt
v_mfma_f32_16x16x32_bf16 v[8:11], v[28:31], v[224:227], v[8:11]
s_waitcnt vmcnt(6)
s_cbranch_vccnz L_fb374
s_waitcnt vmcnt(4)
L_fb374:
buffer_load_dwordx4 v[108:111], v1, s[12:15], s39 offen offset:256 nt
v_mfma_f32_16x16x32_bf16 v[12:15], v[28:31], v[228:231], v[12:15]
s_waitcnt vmcnt(6)
s_cbranch_vccnz L_fb375
s_waitcnt vmcnt(4)
L_fb375:
s_add_u32 s39, s7, 5701632
buffer_load_dwordx4 v[112:115], v1, s[12:15], s39 offen offset:0 nt
v_mfma_f32_16x16x32_bf16 v[16:19], v[28:31], v[232:235], v[16:19]
v_fma_f32 v33, v96, s62, -v2
v_exp_f32 v33, v33
s_nop 0
v_add_f32 v3, v3, v33
v_cvt_pk_bf16_f32 v33, v33, v33
v_and_b32 v28, v33, v4
v_and_b32 v29, v33, v5
v_and_b32 v30, v33, v6
v_and_b32 v31, v33, v7
s_nop 1
s_waitcnt vmcnt(6)
s_cbranch_vccnz L_fb376
s_waitcnt vmcnt(4)
L_fb376:
buffer_load_dwordx4 v[116:119], v1, s[12:15], s39 offen offset:128 nt
s_memrealtime s[88:89]
ds_read_b64 v[252:253], v21 offset:15904
v_mfma_f32_16x16x32_bf16 v[8:11], v[28:31], v[236:239], v[8:11]
s_waitcnt vmcnt(6)
s_cbranch_vccnz L_fb377
s_waitcnt vmcnt(4)
L_fb377:
buffer_load_dwordx4 v[120:123], v1, s[12:15], s39 offen offset:256 nt
s_waitcnt lgkmcnt(0)
v_mov_b32 v255, 5384
v_mul_u32_u24 v253, v255, v253
v_mov_b32 v254, s88
v_lshrrev_b32 v253, 12, v253
ds_write_b64 v21, v[254:255] offset:15872
v_add_u32 v253, v253, v252
v_sub_u32 v253, v254, v253
v_cmp_lt_i32 vcc, 0, v253
v_mfma_f32_16x16x32_bf16 v[12:15], v[28:31], v[240:243], v[12:15]
s_waitcnt vmcnt(6)
s_cbranch_vccnz L_fb378
s_waitcnt vmcnt(4)
L_fb378:
s_add_u32 s39, s7, 5799936
buffer_load_dwordx4 v[124:127], v1, s[12:15], s39 offen offset:0 nt
v_mfma_f32_16x16x32_bf16 v[16:19], v[28:31], v[244:247], v[16:19]
v_fma_f32 v33, v97, s62, -v2
v_exp_f32 v33, v33
s_nop 0
v_add_f32 v3, v3, v33
v_cvt_pk_bf16_f32 v33, v33, v33
v_and_b32 v28, v33, v4
v_and_b32 v29, v33, v5
v_and_b32 v30, v33, v6
v_and_b32 v31, v33, v7
s_nop 1
s_waitcnt vmcnt(6)
s_cbranch_vccnz L_fb379
s_waitcnt vmcnt(4)
L_fb379:
buffer_load_dwordx4 v[128:131], v1, s[12:15], s39 offen offset:128 nt
v_mfma_f32_16x16x32_bf16 v[8:11], v[28:31], v[248:251], v[8:11]
s_waitcnt vmcnt(6)
s_cbranch_vccnz L_fb380
s_waitcnt vmcnt(4)
L_fb380:
buffer_load_dwordx4 v[132:135], v1, s[12:15], s39 offen offset:256 nt
v_mfma_f32_16x16x32_bf16 v[12:15], v[28:31], v[104:107], v[12:15]
s_waitcnt vmcnt(6)
s_cbranch_vccnz L_fb381
s_waitcnt vmcnt(4)
L_fb381:
s_add_u32 s39, s7, 5898240
buffer_load_dwordx4 v[136:139], v1, s[12:15], s39 offen offset:0 nt
v_mfma_f32_16x16x32_bf16 v[16:19], v[28:31], v[108:111], v[16:19]
v_fma_f32 v33, v98, s62, -v2
v_exp_f32 v33, v33
s_nop 0
v_add_f32 v3, v3, v33
v_cvt_pk_bf16_f32 v33, v33, v33
v_and_b32 v28, v33, v4
v_and_b32 v29, v33, v5
v_and_b32 v30, v33, v6
v_and_b32 v31, v33, v7
s_nop 1
s_waitcnt vmcnt(6)
s_cbranch_vccnz L_fb382
s_waitcnt vmcnt(4)
L_fb382:
buffer_load_dwordx4 v[140:143], v1, s[12:15], s39 offen offset:128 nt
s_memrealtime s[88:89]
ds_read_b64 v[252:253], v21 offset:15904
v_mfma_f32_16x16x32_bf16 v[8:11], v[28:31], v[112:115], v[8:11]
s_waitcnt vmcnt(6)
s_cbranch_vccnz L_fb383
s_waitcnt vmcnt(4)
L_fb383:
buffer_load_dwordx4 v[144:147], v1, s[12:15], s39 offen offset:256 nt
s_waitcnt lgkmcnt(0)
v_mov_b32 v255, 5465
v_mul_u32_u24 v253, v255, v253
v_mov_b32 v254, s88
v_lshrrev_b32 v253, 12, v253
ds_write_b64 v21, v[254:255] offset:15872
v_add_u32 v253, v253, v252
v_sub_u32 v253, v254, v253
v_cmp_lt_i32 vcc, 0, v253
v_mfma_f32_16x16x32_bf16 v[12:15], v[28:31], v[116:119], v[12:15]
s_waitcnt vmcnt(6)
s_cbranch_vccnz L_fb384
s_waitcnt vmcnt(4)
L_fb384:
s_add_u32 s39, s7, 5996544
buffer_load_dwordx4 v[148:151], v1, s[12:15], s39 offen offset:0 nt
v_mfma_f32_16x16x32_bf16 v[16:19], v[28:31], v[120:123], v[16:19]
v_fma_f32 v33, v99, s62, -v2
v_exp_f32 v33, v33
s_nop 0
v_add_f32 v3, v3, v33
v_cvt_pk_bf16_f32 v33, v33, v33
v_and_b32 v28, v33, v4
v_and_b32 v29, v33, v5
v_and_b32 v30, v33, v6
v_and_b32 v31, v33, v7
s_nop 1
s_waitcnt vmcnt(6)
s_cbranch_vccnz L_fb385
s_waitcnt vmcnt(4)
L_fb385:
buffer_load_dwordx4 v[152:155], v1, s[12:15], s39 offen offset:128 nt
v_mfma_f32_16x16x32_bf16 v[8:11], v[28:31], v[124:127], v[8:11]
s_waitcnt vmcnt(6)
s_cbranch_vccnz L_fb386
s_waitcnt vmcnt(4)
L_fb386:
buffer_load_dwordx4 v[156:159], v1, s[12:15], s39 offen offset:256 nt
v_mfma_f32_16x16x32_bf16 v[12:15], v[28:31], v[128:131], v[12:15]
s_waitcnt vmcnt(6)
s_cbranch_vccnz L_fb387
s_waitcnt vmcnt(4)
L_fb387:
s_add_u32 s39, s7, 6094848
buffer_load_dwordx4 v[160:163], v1, s[12:15], s39 offen offset:0 nt
v_mfma_f32_16x16x32_bf16 v[16:19], v[28:31], v[132:135], v[16:19]
v_fma_f32 v33, v100, s62, -v2
v_exp_f32 v33, v33
s_nop 0
v_add_f32 v3, v3, v33
v_cvt_pk_bf16_f32 v33, v33, v33
v_and_b32 v28, v33, v4
v_and_b32 v29, v33, v5
v_and_b32 v30, v33, v6
v_and_b32 v31, v33, v7
s_nop 1
s_waitcnt vmcnt(6)
s_cbranch_vccnz L_fb388
s_waitcnt vmcnt(4)
L_fb388:
buffer_load_dwordx4 v[164:167], v1, s[12:15], s39 offen offset:128 nt
s_memrealtime s[88:89]
ds_read_b64 v[252:253], v21 offset:15904
v_mfma_f32_16x16x32_bf16 v[8:11], v[28:31], v[136:139], v[8:11]
s_waitcnt vmcnt(6)
s_cbranch_vccnz L_fb389
s_waitcnt vmcnt(4)
L_fb389:
buffer_load_dwordx4 v[204:207], v1, s[12:15], s39 offen offset:256 nt
s_waitcnt lgkmcnt(0)
v_mov_b32 v255, 5546
v_mul_u32_u24 v253, v255, v253
v_mov_b32 v254, s88
v_lshrrev_b32 v253, 12, v253
ds_write_b64 v21, v[254:255] offset:15872
v_add_u32 v253, v253, v252
v_sub_u32 v253, v254, v253
v_cmp_lt_i32 vcc, 0, v253
v_mfma_f32_16x16x32_bf16 v[12:15], v[28:31], v[140:143], v[12:15]
s_waitcnt vmcnt(6)
s_cbranch_vccnz L_fb390
s_waitcnt vmcnt(4)
L_fb390:
s_add_u32 s39, s7, 6193152
buffer_load_dwordx4 v[208:211], v1, s[12:15], s39 offen offset:0 nt
v_mfma_f32_16x16x32_bf16 v[16:19], v[28:31], v[144:147], v[16:19]
v_fma_f32 v33, v101, s62, -v2
v_exp_f32 v33, v33
s_nop 0
v_add_f32 v3, v3, v33
v_cvt_pk_bf16_f32 v33, v33, v33
v_and_b32 v28, v33, v4
v_and_b32 v29, v33, v5
v_and_b32 v30, v33, v6
v_and_b32 v31, v33, v7
s_nop 1
s_waitcnt vmcnt(6)
s_cbranch_vccnz L_fb391
s_waitcnt vmcnt(4)
L_fb391:
buffer_load_dwordx4 v[212:215], v1, s[12:15], s39 offen offset:128 nt
v_mfma_f32_16x16x32_bf16 v[8:11], v[28:31], v[148:151], v[8:11]
s_waitcnt vmcnt(6)
s_cbranch_vccnz L_fb392
s_waitcnt vmcnt(4)
L_fb392:
buffer_load_dwordx4 v[216:219], v1, s[12:15], s39 offen offset:256 nt
v_mfma_f32_16x16x32_bf16 v[12:15], v[28:31], v[152:155], v[12:15]
s_waitcnt vmcnt(6)
v_mfma_f32_16x16x32_bf16 v[16:19], v[28:31], v[156:159], v[16:19]
v_fma_f32 v33, v102, s62, -v2
v_exp_f32 v33, v33
s_nop 0
v_add_f32 v3, v3, v33
v_cvt_pk_bf16_f32 v33, v33, v33
v_and_b32 v28, v33, v4
v_and_b32 v29, v33, v5
v_and_b32 v30, v33, v6
v_and_b32 v31, v33, v7
s_nop 1
s_waitcnt vmcnt(5)
v_mfma_f32_16x16x32_bf16 v[8:11], v[28:31], v[160:163], v[8:11]
s_waitcnt vmcnt(4)
v_mfma_f32_16x16x32_bf16 v[12:15], v[28:31], v[164:167], v[12:15]
s_waitcnt vmcnt(3)
v_mfma_f32_16x16x32_bf16 v[16:19], v[28:31], v[204:207], v[16:19]
v_fma_f32 v33, v103, s62, -v2
v_exp_f32 v33, v33
s_nop 0
v_add_f32 v3, v3, v33
v_cvt_pk_bf16_f32 v33, v33, v33
v_and_b32 v28, v33, v4
v_and_b32 v29, v33, v5
v_and_b32 v30, v33, v6
v_and_b32 v31, v33, v7
s_nop 1
v_add_f32_dpp v3, v3, v3 row_ror:8 row_mask:0xf bank_mask:0xf
v_mov_b32 v33, v3
s_nop 1
v_permlane16_swap_b32 v33, v3
v_add_f32 v3, v33, v3
v_mov_b32 v33, v3
s_nop 1
v_permlane32_swap_b32 v33, v3
v_add_f32 v3, v33, v3
s_nop 1
s_waitcnt vmcnt(2)
v_mfma_f32_16x16x32_bf16 v[8:11], v[28:31], v[208:211], v[8:11]
s_waitcnt vmcnt(1)
v_mfma_f32_16x16x32_bf16 v[12:15], v[28:31], v[212:215], v[12:15]
s_waitcnt vmcnt(0)
v_mfma_f32_16x16x32_bf16 v[16:19], v[28:31], v[216:219], v[16:19]
ds_write_b64 v21, v[2:3] offset:14464
s_mov_b64 exec, s[36:37]
s_nop 5
ds_write_b128 v20, v[8:11] offset:8320
ds_write_b128 v20, v[12:15] offset:8576
ds_write_b128 v20, v[16:19] offset:8832
s_mov_b64 exec, -1
s_waitcnt lgkmcnt(0)
s_barrier
ds_read_b128 v[84:87], v25 offset:3200
ds_read_b128 v[88:91], v25 offset:5760
s_cmp_eq_u32 s3, 1
s_cbranch_scc1 L_poller1
s_cmp_lg_u32 s3, 0
s_cbranch_scc1 L_b3
ds_read_b128 v[40:43], v21 offset:14464
ds_read_b128 v[44:47], v21 offset:14480
ds_read2_b32 v[48:49], v24 offset0:0 offset1:192
ds_read2_b32 v[50:51], v24 offset0:8 offset1:200
ds_read2_b32 v[52:53], v24 offset0:16 offset1:208
v_add_u32 v93, 1536, v24
ds_read2_b32 v[54:55], v93 offset0:0 offset1:192
ds_read2_b32 v[56:57], v93 offset0:8 offset1:200
ds_read2_b32 v[58:59], v93 offset0:16 offset1:208
v_add_u32 v94, 3072, v24
ds_read2_b32 v[60:61], v94 offset0:0 offset1:192
ds_read2_b32 v[62:63], v94 offset0:8 offset1:200
ds_read2_b32 v[64:65], v94 offset0:16 offset1:208
v_add_u32 v95, 4608, v24
ds_read2_b32 v[66:67], v95 offset0:0 offset1:192
ds_read2_b32 v[68:69], v95 offset0:8 offset1:200
ds_read2_b32 v[70:71], v95 offset0:16 offset1:208
s_waitcnt lgkmcnt(12)
v_max3_f32 v72, v40, v42, v44
v_max_f32 v72, v72, v46
v_and_b32 v72, s95, v72
v_sub_f32 v40, v40, v72
v_sub_f32 v42, v42, v72
v_sub_f32 v44, v44, v72
v_sub_f32 v46, v46, v72
v_exp_f32 v40, v40
v_exp_f32 v42, v42
v_exp_f32 v44, v44
v_exp_f32 v46, v46
s_mov_b32 vcc_lo, 0xaaaaaaaa
s_mov_b32 vcc_hi, 0xaaaaaaaa
v_mul_f32 v73, v40, v41
v_fmac_f32 v73, v42, v43
v_fmac_f32 v73, v44, v45
v_fmac_f32 v73, v46, v47
v_cndmask_b32 v79, v72, v73, vcc
s_waitcnt lgkmcnt(0)
v_add_f32 v48, v48, v49
v_add_f32 v50, v50, v51
v_add_f32 v52, v52, v53
v_add_f32 v54, v54, v55
v_add_f32 v56, v56, v57
v_add_f32 v58, v58, v59
v_add_f32 v60, v60, v61
v_add_f32 v62, v62, v63
v_add_f32 v64, v64, v65
v_add_f32 v66, v66, v67
v_add_f32 v68, v68, v69
v_add_f32 v70, v70, v71
v_mul_f32 v76, v40, v48
v_mul_f32 v77, v40, v50
v_mul_f32 v78, v40, v52
v_fmac_f32 v76, v42, v54
v_fmac_f32 v77, v42, v56
v_fmac_f32 v78, v42, v58
v_fmac_f32 v76, v44, v60
v_fmac_f32 v77, v44, v62
v_fmac_f32 v78, v44, v64
v_fmac_f32 v76, v46, v66
v_fmac_f32 v77, v46, v68
v_fmac_f32 v78, v46, v70
v_and_or_b32 v76, v76, s95, v27
v_and_or_b32 v77, v77, s95, v27
v_and_or_b32 v78, v78, s95, v27
v_and_or_b32 v79, v79, s95, v27
s_mov_b64 exec, s[98:99]
s_cmp_eq_u32 s34, 1
s_cbranch_scc1 L_oloc
buffer_store_dwordx4 v[76:79], v23, s[16:19], s92 offen sc1
s_branch L_odone
L_oloc:
buffer_store_dwordx4 v[76:79], v23, s[16:19], s92 offen
L_odone:
s_not_b64 exec, exec
ds_write_b128 v22, v[76:79] offset:14592
s_mov_b64 exec, -1
s_branch L_b3
L_poller1:
v_cmp_ne_u32 vcc, s6, v37
s_mov_b64 exec, vcc
s_mov_b32 s38, 1048576
buffer_load_dwordx4 v[40:43], v22, s[16:19], s91 offen sc1
s_sleep 3
buffer_load_dwordx4 v[44:47], v22, s[16:19], s91 offen sc1
L_poll1:
s_waitcnt vmcnt(1)
v_perm_b32 v60, v41, v40, s100
v_perm_b32 v60, v42, v60, s101
v_perm_b32 v60, v43, v60, s59
v_cmp_eq_u32 vcc, s94, v60
s_andn2_b64 s[96:97], exec, vcc
s_mov_b64 exec, vcc
ds_write_b128 v39, v[40:43] offset:14592
s_mov_b64 exec, s[96:97]
s_cbranch_execz L_got1
s_waitcnt lgkmcnt(0)
buffer_load_dwordx4 v[40:43], v22, s[16:19], s91 offen sc1
s_waitcnt vmcnt(1)
v_perm_b32 v60, v45, v44, s100
v_perm_b32 v60, v46, v60, s101
v_perm_b32 v60, v47, v60, s59
v_cmp_eq_u32 vcc, s94, v60
s_andn2_b64 s[96:97], exec, vcc
s_mov_b64 exec, vcc
ds_write_b128 v39, v[44:47] offset:14592
s_mov_b64 exec, s[96:97]
s_cbranch_execz L_got1
s_waitcnt lgkmcnt(0)
buffer_load_dwordx4 v[44:47], v22, s[16:19], s91 offen sc1
s_sub_u32 s38, s38, 1
s_cbranch_scc0 L_poll1
L_got1:
s_mov_b64 exec, -1
L_b3:
s_waitcnt lgkmcnt(0)
s_barrier
ds_read_b128 v[92:95], v39 offset:14592
v_add_f32 v84, v84, v88
v_add_f32 v85, v85, v89
v_add_f32 v86, v86, v90
v_add_f32 v87, v87, v91
s_waitcnt lgkmcnt(0)
v_and_b32 v95, s95, v95
v_and_b32 v92, s95, v92
v_and_b32 v93, s95, v93
v_and_b32 v94, s95, v94
v_mov_b32 v96, v95
v_mov_b32 v97, v95
s_nop 0
v_mov_b32_dpp v96, v95 row_ror:8 row_mask:0xf bank_mask:0xc
v_mov_b32_dpp v97, v95 row_ror:8 row_mask:0xf bank_mask:0x3
v_mov_b32 v98, v96
s_nop 1
v_max_f32_dpp v98, v98, v98 quad_perm:[1,0,3,2] row_mask:0xf bank_mask:0xf
s_nop 1
v_max_f32_dpp v98, v98, v98 quad_perm:[2,3,0,1] row_mask:0xf bank_mask:0xf
s_nop 1
v_max_f32_dpp v98, v98, v98 row_half_mirror row_mask:0xf bank_mask:0xf
v_sub_f32 v96, v96, v98
v_exp_f32 v96, v96
s_nop 0
v_mul_f32 v95, v96, v97
v_mul_f32 v92, v96, v92
v_mul_f32 v93, v96, v93
v_mul_f32 v94, v96, v94
s_nop 0
v_add_f32_dpp v95, v95, v95 quad_perm:[1,0,3,2] row_mask:0xf bank_mask:0xf
v_add_f32_dpp v92, v92, v92 quad_perm:[1,0,3,2] row_mask:0xf bank_mask:0xf
v_add_f32_dpp v93, v93, v93 quad_perm:[1,0,3,2] row_mask:0xf bank_mask:0xf
v_add_f32_dpp v94, v94, v94 quad_perm:[1,0,3,2] row_mask:0xf bank_mask:0xf
v_add_f32_dpp v95, v95, v95 quad_perm:[2,3,0,1] row_mask:0xf bank_mask:0xf
v_add_f32_dpp v92, v92, v92 quad_perm:[2,3,0,1] row_mask:0xf bank_mask:0xf
v_add_f32_dpp v93, v93, v93 quad_perm:[2,3,0,1] row_mask:0xf bank_mask:0xf
v_add_f32_dpp v94, v94, v94 quad_perm:[2,3,0,1] row_mask:0xf bank_mask:0xf
v_add_f32_dpp v95, v95, v95 row_half_mirror row_mask:0xf bank_mask:0xf
v_add_f32_dpp v92, v92, v92 row_half_mirror row_mask:0xf bank_mask:0xf
v_add_f32_dpp v93, v93, v93 row_half_mirror row_mask:0xf bank_mask:0xf
v_add_f32_dpp v94, v94, v94 row_half_mirror row_mask:0xf bank_mask:0xf
v_rcp_f32 v95, v95
s_nop 0
v_mul_f32 v92, v95, v92
v_mul_f32 v93, v95, v93
v_mul_f32 v94, v95, v94
v_cvt_pk_bf16_f32 v92, v92, v92
v_cvt_pk_bf16_f32 v93, v93, v93
v_cvt_pk_bf16_f32 v94, v94, v94
v_and_b32 v8, v92, v4
v_and_b32 v9, v92, v5
v_and_b32 v10, v92, v6
v_and_b32 v11, v92, v7
v_and_b32 v12, v93, v4
v_and_b32 v13, v93, v5
v_and_b32 v14, v93, v6
v_and_b32 v15, v93, v7
v_and_b32 v16, v94, v4
v_and_b32 v17, v94, v5
v_and_b32 v18, v94, v6
v_and_b32 v19, v94, v7
s_nop 1
v_mfma_f32_16x16x32_bf16 v[60:63], v[8:11], v[168:171], 0
v_mfma_f32_16x16x32_bf16 v[64:67], v[8:11], v[172:175], 0
v_mfma_f32_16x16x32_bf16 v[68:71], v[8:11], v[176:179], 0
v_mfma_f32_16x16x32_bf16 v[60:63], v[12:15], v[180:183], v[60:63]
v_mfma_f32_16x16x32_bf16 v[64:67], v[12:15], v[184:187], v[64:67]
v_mfma_f32_16x16x32_bf16 v[68:71], v[12:15], v[188:191], v[68:71]
v_mfma_f32_16x16x32_bf16 v[60:63], v[16:19], v[192:195], v[60:63]
v_mfma_f32_16x16x32_bf16 v[64:67], v[16:19], v[196:199], v[64:67]
v_mfma_f32_16x16x32_bf16 v[68:71], v[16:19], v[200:203], v[68:71]
s_nop 7
v_permlane32_swap_b32 v60, v64
v_permlane32_swap_b32 v61, v65
v_permlane32_swap_b32 v62, v66
v_permlane32_swap_b32 v63, v67
v_mov_b32 v72, v68
v_mov_b32 v73, v69
v_mov_b32 v74, v70
v_mov_b32 v75, v71
s_nop 1
v_permlane32_swap_b32 v68, v72
v_permlane32_swap_b32 v69, v73
v_permlane32_swap_b32 v70, v74
v_permlane32_swap_b32 v71, v75
v_add_f32_dpp v76, v64, v60 row_ror:8 row_mask:0xf bank_mask:0xf
v_add_f32_dpp v77, v65, v61 row_ror:8 row_mask:0xf bank_mask:0xf
v_add_f32_dpp v78, v66, v62 row_ror:8 row_mask:0xf bank_mask:0xf
v_add_f32_dpp v79, v67, v63 row_ror:8 row_mask:0xf bank_mask:0xf
v_add_f32_dpp v76, v68, v72 row_ror:8 row_mask:0xf bank_mask:0xc
v_add_f32_dpp v77, v69, v73 row_ror:8 row_mask:0xf bank_mask:0xc
v_add_f32_dpp v78, v70, v74 row_ror:8 row_mask:0xf bank_mask:0xc
v_add_f32_dpp v79, v71, v75 row_ror:8 row_mask:0xf bank_mask:0xc
v_add_f32 v76, v76, v84
v_add_f32 v77, v77, v85
v_add_f32 v78, v78, v86
v_add_f32 v79, v79, v87
v_and_or_b32 v76, v76, s95, v27
v_and_or_b32 v77, v77, s95, v27
v_and_or_b32 v78, v78, s95, v27
v_and_or_b32 v79, v79, s95, v27
buffer_store_dwordx4 v[76:79], v26, s[16:19], s93 offen sc1
s_cmp_ge_u32 s2, 40
s_cbranch_scc1 L_fin
s_lshl_b32 s91, s2, 14
s_lshl_b32 s38, s3, 12
s_add_u32 s91, s91, s38
s_add_u32 s91, s91, 1048576
s_mov_b32 s8, s64
s_mov_b32 s9, s65
s_mov_b32 s10, 1280
s_mov_b32 s11, 0x20000
v_lshlrev_b32 v61, 3, v0
buffer_load_dwordx2 v[100:101], v61, s[8:11], s90 offen
s_mov_b64 s[28:29], -1
s_mov_b64 s[30:31], -1
s_mov_b64 s[32:33], -1
s_mov_b64 s[34:35], -1
s_mov_b32 s38, 1048576
s_waitcnt vmcnt(0)
L_poll2:
s_mov_b64 exec, s[28:29]
buffer_load_dwordx4 v[40:43], v39, s[16:19], s91 offen offset:0 sc1
s_mov_b64 exec, s[30:31]
buffer_load_dwordx4 v[44:47], v39, s[16:19], s91 offen offset:1024 sc1
s_mov_b64 exec, s[32:33]
buffer_load_dwordx4 v[48:51], v39, s[16:19], s91 offen offset:2048 sc1
s_mov_b64 exec, s[34:35]
buffer_load_dwordx4 v[52:55], v39, s[16:19], s91 offen offset:3072 sc1
s_mov_b64 exec, -1
s_waitcnt vmcnt(3)
v_perm_b32 v56, v41, v40, s100
v_perm_b32 v56, v42, v56, s101
v_perm_b32 v56, v43, v56, s59
v_cmp_ne_u32 s[28:29], s94, v56
s_waitcnt vmcnt(2)
v_perm_b32 v57, v45, v44, s100
v_perm_b32 v57, v46, v57, s101
v_perm_b32 v57, v47, v57, s59
v_cmp_ne_u32 s[30:31], s94, v57
s_waitcnt vmcnt(1)
v_perm_b32 v58, v49, v48, s100
v_perm_b32 v58, v50, v58, s101
v_perm_b32 v58, v51, v58, s59
v_cmp_ne_u32 s[32:33], s94, v58
s_waitcnt vmcnt(0)
v_perm_b32 v59, v53, v52, s100
v_perm_b32 v59, v54, v59, s101
v_perm_b32 v59, v55, v59, s59
v_cmp_ne_u32 s[34:35], s94, v59
s_or_b64 s[96:97], s[28:29], s[30:31]
s_or_b64 vcc, s[32:33], s[34:35]
s_or_b64 vcc, vcc, s[96:97]
s_cbranch_scc0 L_got2
s_sub_u32 s38, s38, 1
s_cbranch_scc0 L_poll2
L_got2:
v_and_b32 v40, s95, v40
v_and_b32 v41, s95, v41
v_and_b32 v42, s95, v42
v_and_b32 v43, s95, v43
v_and_b32 v44, s95, v44
v_and_b32 v45, s95, v45
v_and_b32 v46, s95, v46
v_and_b32 v47, s95, v47
v_and_b32 v48, s95, v48
v_and_b32 v49, s95, v49
v_and_b32 v50, s95, v50
v_and_b32 v51, s95, v51
v_and_b32 v52, s95, v52
v_and_b32 v53, s95, v53
v_and_b32 v54, s95, v54
v_and_b32 v55, s95, v55
v_add_f32 v40, v40, v44
v_add_f32 v48, v48, v52
v_add_f32 v41, v41, v45
v_add_f32 v49, v49, v53
v_add_f32 v42, v42, v46
v_add_f32 v50, v50, v54
v_add_f32 v43, v43, v47
v_add_f32 v51, v51, v55
v_add_f32 v40, v40, v48
v_add_f32 v41, v41, v49
v_add_f32 v42, v42, v50
v_add_f32 v43, v43, v51
v_add_f32_dpp v40, v40, v40 row_ror:4 row_mask:0xf bank_mask:0xf
v_add_f32_dpp v41, v41, v41 row_ror:4 row_mask:0xf bank_mask:0xf
v_add_f32_dpp v42, v42, v42 row_ror:4 row_mask:0xf bank_mask:0xf
v_add_f32_dpp v43, v43, v43 row_ror:4 row_mask:0xf bank_mask:0xf
v_add_f32_dpp v40, v40, v40 row_ror:8 row_mask:0xf bank_mask:0xf
v_add_f32_dpp v41, v41, v41 row_ror:8 row_mask:0xf bank_mask:0xf
v_add_f32_dpp v42, v42, v42 row_ror:8 row_mask:0xf bank_mask:0xf
v_add_f32_dpp v43, v43, v43 row_ror:8 row_mask:0xf bank_mask:0xf
v_mov_b32 v44, v40
v_mov_b32 v45, v41
v_mov_b32 v46, v42
v_mov_b32 v47, v43
s_nop 1
v_permlane16_swap_b32 v44, v40
v_permlane16_swap_b32 v45, v41
v_permlane16_swap_b32 v46, v42
v_permlane16_swap_b32 v47, v43
v_add_f32 v40, v44, v40
v_add_f32 v41, v45, v41
v_add_f32 v42, v46, v42
v_add_f32 v43, v47, v43
v_mov_b32 v44, v40
v_mov_b32 v45, v41
v_mov_b32 v46, v42
v_mov_b32 v47, v43
s_nop 1
v_permlane32_swap_b32 v44, v40
v_permlane32_swap_b32 v45, v41
v_permlane32_swap_b32 v46, v42
v_permlane32_swap_b32 v47, v43
v_add_f32 v40, v44, v40
v_add_f32 v41, v45, v41
v_add_f32 v42, v46, v42
v_add_f32 v43, v47, v43
s_lshl_b32 s38, s3, 6
v_add_u32 v44, s38, v39
s_mov_b64 exec, 15
ds_write_b128 v44, v[40:43] offset:15616
s_waitcnt lgkmcnt(0)
s_barrier
s_cmp_lg_u32 s3, 0
s_cbranch_scc1 L_noep
ds_read_b128 v[44:47], v39 offset:15680
ds_read_b128 v[48:51], v39 offset:15744
ds_read_b128 v[52:55], v39 offset:15808
v_lshlrev_b32 v56, 16, v100
v_and_b32 v57, s60, v100
v_lshlrev_b32 v58, 16, v101
v_and_b32 v59, s60, v101
v_mov_b32 v62, s63
s_waitcnt lgkmcnt(0)
v_add_f32 v40, v40, v44
v_add_f32 v48, v48, v52
v_add_f32 v41, v41, v45
v_add_f32 v49, v49, v53
v_add_f32 v42, v42, v46
v_add_f32 v50, v50, v54
v_add_f32 v43, v43, v47
v_add_f32 v51, v51, v55
v_add_f32 v40, v40, v48
v_add_f32 v41, v41, v49
v_add_f32 v42, v42, v50
v_add_f32 v43, v43, v51
v_add_f32 v40, v56, v40
v_add_f32 v41, v57, v41
v_add_f32 v42, v58, v42
v_add_f32 v43, v59, v43
v_cvt_pk_bf16_f32 v40, v40, v41
v_cvt_pk_bf16_f32 v41, v42, v43
buffer_store_dwordx2 v[40:41], v61, s[24:27], s90 offen
s_cmp_lg_u32 s2, 0
s_cbranch_scc1 L_noep
s_and_b64 exec, exec, 1
buffer_store_dword v62, v21, s[16:19], 0 offen
L_noep:
s_mov_b64 exec, -1
s_endpgm
L_helper:
s_setprio 3
v_lshlrev_b32 v1, 2, v0
v_mul_u32_u24 v2, 12288, v36
v_add_u32 v2, v2, v38
s_mul_i32 s7, s6, 983040
s_mul_i32 s38, s5, 384
s_add_u32 s7, s7, s38
s_waitcnt lgkmcnt(0)
s_mov_b32 s98, s28
s_mov_b32 s8, s64
s_mov_b32 s9, s65
s_mov_b32 s10, 1280
s_mov_b32 s11, 0x20000
s_mov_b32 s20, s70
s_mov_b32 s21, s71
s_mov_b32 s22, 7864320
s_mov_b32 s23, 0x20000
buffer_load_dword v40, v1, s[8:11], 0 offen offset:0
buffer_load_dword v41, v1, s[8:11], 0 offen offset:256
buffer_load_dword v42, v1, s[8:11], 0 offen offset:512
buffer_load_dword v43, v1, s[8:11], 0 offen offset:768
buffer_load_dword v44, v1, s[8:11], 0 offen offset:1024
buffer_load_dwordx4 v[100:103], v2, s[20:23], s7 offen offset:0 nt
buffer_load_dwordx4 v[104:107], v2, s[20:23], s7 offen offset:128 nt
buffer_load_dwordx4 v[108:111], v2, s[20:23], s7 offen offset:256 nt
s_add_u32 s7, s7, 98304
buffer_load_dwordx4 v[112:115], v2, s[20:23], s7 offen offset:0 nt
buffer_load_dwordx4 v[116:119], v2, s[20:23], s7 offen offset:128 nt
buffer_load_dwordx4 v[120:123], v2, s[20:23], s7 offen offset:256 nt
s_add_u32 s7, s7, 98304
buffer_load_dwordx4 v[124:127], v2, s[20:23], s7 offen offset:0 nt
buffer_load_dwordx4 v[128:131], v2, s[20:23], s7 offen offset:128 nt
buffer_load_dwordx4 v[132:135], v2, s[20:23], s7 offen offset:256 nt
s_add_u32 s7, s7, 98304
buffer_load_dwordx4 v[136:139], v2, s[20:23], s7 offen offset:0 nt
buffer_load_dwordx4 v[140:143], v2, s[20:23], s7 offen offset:128 nt
buffer_load_dwordx4 v[144:147], v2, s[20:23], s7 offen offset:256 nt
s_add_u32 s7, s7, 98304
buffer_load_dwordx4 v[148:151], v2, s[20:23], s7 offen offset:0 nt
buffer_load_dwordx4 v[152:155], v2, s[20:23], s7 offen offset:128 nt
buffer_load_dwordx4 v[156:159], v2, s[20:23], s7 offen offset:256 nt
s_add_u32 s7, s7, 98304
buffer_load_dwordx4 v[160:163], v2, s[20:23], s7 offen offset:0 nt
buffer_load_dwordx4 v[164:167], v2, s[20:23], s7 offen offset:128 nt
buffer_load_dwordx4 v[168:171], v2, s[20:23], s7 offen offset:256 nt
s_add_u32 s7, s7, 98304
buffer_load_dwordx4 v[172:175], v2, s[20:23], s7 offen offset:0 nt
buffer_load_dwordx4 v[176:179], v2, s[20:23], s7 offen offset:128 nt
buffer_load_dwordx4 v[180:183], v2, s[20:23], s7 offen offset:256 nt
s_add_u32 s7, s7, 98304
buffer_load_dwordx4 v[184:187], v2, s[20:23], s7 offen offset:0 nt
buffer_load_dwordx4 v[188:191], v2, s[20:23], s7 offen offset:128 nt
buffer_load_dwordx4 v[192:195], v2, s[20:23], s7 offen offset:256 nt
s_add_u32 s7, s7, 98304
buffer_load_dwordx4 v[196:199], v2, s[20:23], s7 offen offset:0 nt
buffer_load_dwordx4 v[200:203], v2, s[20:23], s7 offen offset:128 nt
buffer_load_dwordx4 v[204:207], v2, s[20:23], s7 offen offset:256 nt
s_add_u32 s7, s7, 98304
buffer_load_dwordx4 v[208:211], v2, s[20:23], s7 offen offset:0 nt
buffer_load_dwordx4 v[212:215], v2, s[20:23], s7 offen offset:128 nt
buffer_load_dwordx4 v[216:219], v2, s[20:23], s7 offen offset:256 nt
s_load_dword s63, s[86:87], 0
s_mov_b32 s16, s86
s_mov_b32 s17, s87
s_mov_b32 s18, 805306368
s_mov_b32 s19, 0x20000
s_mov_b32 s24, s76
s_mov_b32 s25, s77
s_mov_b32 s26, 1966080
s_mov_b32 s27, 0x20000
s_mov_b32 s28, s78
s_mov_b32 s29, s79
s_mov_b32 s30, 1966080
s_mov_b32 s31, 0x20000
s_mov_b32 s32, s80
s_mov_b32 s33, s81
s_mov_b32 s34, 1966080
s_mov_b32 s35, 0x20000
s_waitcnt vmcnt(30)
v_lshlrev_b32 v50, 16, v40
v_and_b32 v51, s60, v40
v_lshlrev_b32 v52, 16, v41
v_and_b32 v53, s60, v41
v_lshlrev_b32 v54, 16, v42
v_and_b32 v55, s60, v42
v_lshlrev_b32 v56, 16, v43
v_and_b32 v57, s60, v43
v_lshlrev_b32 v58, 16, v44
v_and_b32 v59, s60, v44
v_add_f32 v45, v50, v51
v_add_f32 v45, v45, v52
v_add_f32 v45, v45, v53
v_add_f32 v45, v45, v54
v_add_f32 v45, v45, v55
v_add_f32 v45, v45, v56
v_add_f32 v45, v45, v57
v_add_f32 v45, v45, v58
v_add_f32 v45, v45, v59
s_nop 1
v_add_f32_dpp v45, v45, v45 quad_perm:[1,0,3,2] row_mask:0xf bank_mask:0xf
s_nop 1
v_add_f32_dpp v45, v45, v45 quad_perm:[2,3,0,1] row_mask:0xf bank_mask:0xf
s_nop 1
v_add_f32_dpp v45, v45, v45 row_half_mirror row_mask:0xf bank_mask:0xf
s_nop 1
v_add_f32_dpp v45, v45, v45 row_ror:8 row_mask:0xf bank_mask:0xf
v_mov_b32 v46, v45
s_nop 1
v_permlane16_swap_b32 v46, v45
v_add_f32 v45, v46, v45
v_mov_b32 v46, v45
s_nop 1
v_permlane32_swap_b32 v46, v45
v_add_f32 v45, v46, v45
v_mul_f32 v45, 0x3acccccd, v45
v_sub_f32 v47, v50, v45
v_mul_f32 v46, v47, v47
v_sub_f32 v47, v51, v45
v_fmac_f32 v46, v47, v47
v_sub_f32 v47, v52, v45
v_fmac_f32 v46, v47, v47
v_sub_f32 v47, v53, v45
v_fmac_f32 v46, v47, v47
v_sub_f32 v47, v54, v45
v_fmac_f32 v46, v47, v47
v_sub_f32 v47, v55, v45
v_fmac_f32 v46, v47, v47
v_sub_f32 v47, v56, v45
v_fmac_f32 v46, v47, v47
v_sub_f32 v47, v57, v45
v_fmac_f32 v46, v47, v47
v_sub_f32 v47, v58, v45
v_fmac_f32 v46, v47, v47
v_sub_f32 v47, v59, v45
v_fmac_f32 v46, v47, v47
s_nop 1
v_add_f32_dpp v46, v46, v46 quad_perm:[1,0,3,2] row_mask:0xf bank_mask:0xf
s_nop 1
v_add_f32_dpp v46, v46, v46 quad_perm:[2,3,0,1] row_mask:0xf bank_mask:0xf
s_nop 1
v_add_f32_dpp v46, v46, v46 row_half_mirror row_mask:0xf bank_mask:0xf
s_nop 1
v_add_f32_dpp v46, v46, v46 row_ror:8 row_mask:0xf bank_mask:0xf
v_mov_b32 v47, v46
s_nop 1
v_permlane16_swap_b32 v47, v46
v_add_f32 v46, v47, v46
v_mov_b32 v47, v46
s_nop 1
v_permlane32_swap_b32 v47, v46
v_add_f32 v46, v47, v46
v_mul_f32 v46, 0x3acccccd, v46
v_cvt_pk_bf16_f32 v45, v45, v45
v_and_b32 v45, s60, v45
v_cvt_pk_bf16_f32 v46, v46, v46
v_and_b32 v46, s60, v46
v_add_f32 v46, 0x3727c5ac, v46
v_cvt_pk_bf16_f32 v46, v46, v46
v_and_b32 v46, s60, v46
v_sqrt_f32 v46, v46
s_nop 0
v_cvt_pk_bf16_f32 v46, v46, v46
v_and_b32 v46, s60, v46
v_rcp_f32 v47, v46
v_sub_f32 v50, v50, v45
v_cvt_pk_bf16_f32 v50, v50, v50
v_and_b32 v50, s60, v50
v_sub_f32 v51, v51, v45
v_cvt_pk_bf16_f32 v51, v51, v51
v_and_b32 v51, s60, v51
v_sub_f32 v52, v52, v45
v_cvt_pk_bf16_f32 v52, v52, v52
v_and_b32 v52, s60, v52
v_sub_f32 v53, v53, v45
v_cvt_pk_bf16_f32 v53, v53, v53
v_and_b32 v53, s60, v53
v_sub_f32 v54, v54, v45
v_cvt_pk_bf16_f32 v54, v54, v54
v_and_b32 v54, s60, v54
v_sub_f32 v55, v55, v45
v_cvt_pk_bf16_f32 v55, v55, v55
v_and_b32 v55, s60, v55
v_sub_f32 v56, v56, v45
v_cvt_pk_bf16_f32 v56, v56, v56
v_and_b32 v56, s60, v56
v_sub_f32 v57, v57, v45
v_cvt_pk_bf16_f32 v57, v57, v57
v_and_b32 v57, s60, v57
v_sub_f32 v58, v58, v45
v_cvt_pk_bf16_f32 v58, v58, v58
v_and_b32 v58, s60, v58
v_sub_f32 v59, v59, v45
v_cvt_pk_bf16_f32 v59, v59, v59
v_and_b32 v59, s60, v59
v_mul_f32 v48, v50, v47
v_fma_f32 v49, -v48, v46, v50
v_fma_f32 v50, v49, v47, v48
v_mul_f32 v48, v51, v47
v_fma_f32 v49, -v48, v46, v51
v_fma_f32 v51, v49, v47, v48
v_mul_f32 v48, v52, v47
v_fma_f32 v49, -v48, v46, v52
v_fma_f32 v52, v49, v47, v48
v_mul_f32 v48, v53, v47
v_fma_f32 v49, -v48, v46, v53
v_fma_f32 v53, v49, v47, v48
v_mul_f32 v48, v54, v47
v_fma_f32 v49, -v48, v46, v54
v_fma_f32 v54, v49, v47, v48
v_mul_f32 v48, v55, v47
v_fma_f32 v49, -v48, v46, v55
v_fma_f32 v55, v49, v47, v48
v_mul_f32 v48, v56, v47
v_fma_f32 v49, -v48, v46, v56
v_fma_f32 v56, v49, v47, v48
v_mul_f32 v48, v57, v47
v_fma_f32 v49, -v48, v46, v57
v_fma_f32 v57, v49, v47, v48
v_mul_f32 v48, v58, v47
v_fma_f32 v49, -v48, v46, v58
v_fma_f32 v58, v49, v47, v48
v_mul_f32 v48, v59, v47
v_fma_f32 v49, -v48, v46, v59
v_fma_f32 v59, v49, v47, v48
v_cvt_pk_bf16_f32 v40, v50, v51
ds_write_b32 v1, v40 offset:0
v_cvt_pk_bf16_f32 v41, v52, v53
ds_write_b32 v1, v41 offset:256
v_cvt_pk_bf16_f32 v42, v54, v55
ds_write_b32 v1, v42 offset:512
v_cvt_pk_bf16_f32 v43, v56, v57
ds_write_b32 v1, v43 offset:768
v_cvt_pk_bf16_f32 v44, v58, v59
ds_write_b32 v1, v44 offset:1024
s_mul_i32 s38, s6, 160
v_lshlrev_b32 v3, 1, v36
v_add_u32 v3, s38, v3
ds_read_u16 v60, v3 offset:0
ds_read_u16 v61, v3 offset:16
ds_read_u16 v62, v3 offset:32
ds_read_u16 v63, v3 offset:48
ds_read_u16 v64, v3 offset:64
ds_read_u16 v65, v3 offset:80
ds_read_u16 v66, v3 offset:96
ds_read_u16 v67, v3 offset:112
ds_read_u16 v68, v3 offset:128
ds_read_u16 v69, v3 offset:144
v_lshrrev_b32 v20, 5, v0
v_mul_u32_u24 v20, 768, v20
v_lshlrev_b32 v21, 5, v37
v_add_u32 v20, v20, v21
v_and_b32 v21, 16, v0
v_add_u32 v20, v20, v21
v_mul_u32_u24 v21, 12, v0
v_add_u32 v21, 1280, v21
v_lshlrev_b32 v22, 4, v0
s_waitcnt lgkmcnt(0)
s_add_u32 s63, s63, 0x9E3779B9
s_xor_b32 s63, s63, 1
v_lshl_or_b32 v60, v60, 16, v60
v_lshl_or_b32 v61, v61, 16, v61
v_lshl_or_b32 v62, v62, 16, v62
v_lshl_or_b32 v63, v63, 16, v63
v_lshl_or_b32 v64, v64, 16, v64
v_lshl_or_b32 v65, v65, 16, v65
v_lshl_or_b32 v66, v66, 16, v66
v_lshl_or_b32 v67, v67, 16, v67
v_lshl_or_b32 v68, v68, 16, v68
v_lshl_or_b32 v69, v69, 16, v69
v_and_b32 v28, v60, v4
v_and_b32 v29, v60, v5
v_and_b32 v30, v60, v6
v_and_b32 v31, v60, v7
s_waitcnt vmcnt(27)
s_nop 0
v_mfma_f32_16x16x32_bf16 v[8:11], v[28:31], v[100:103], 0
v_mfma_f32_16x16x32_bf16 v[12:15], v[28:31], v[104:107], 0
v_mfma_f32_16x16x32_bf16 v[16:19], v[28:31], v[108:111], 0
v_and_b32 v32, v61, v4
v_and_b32 v33, v61, v5
v_and_b32 v34, v61, v6
v_and_b32 v35, v61, v7
s_waitcnt vmcnt(24)
s_nop 0
v_mfma_f32_16x16x32_bf16 v[8:11], v[32:35], v[112:115], v[8:11]
v_mfma_f32_16x16x32_bf16 v[12:15], v[32:35], v[116:119], v[12:15]
v_mfma_f32_16x16x32_bf16 v[16:19], v[32:35], v[120:123], v[16:19]
v_and_b32 v28, v62, v4
v_and_b32 v29, v62, v5
v_and_b32 v30, v62, v6
v_and_b32 v31, v62, v7
s_waitcnt vmcnt(21)
s_nop 0
v_mfma_f32_16x16x32_bf16 v[8:11], v[28:31], v[124:127], v[8:11]
v_mfma_f32_16x16x32_bf16 v[12:15], v[28:31], v[128:131], v[12:15]
v_mfma_f32_16x16x32_bf16 v[16:19], v[28:31], v[132:135], v[16:19]
v_and_b32 v32, v63, v4
v_and_b32 v33, v63, v5
v_and_b32 v34, v63, v6
v_and_b32 v35, v63, v7
s_waitcnt vmcnt(18)
s_nop 0
v_mfma_f32_16x16x32_bf16 v[8:11], v[32:35], v[136:139], v[8:11]
v_mfma_f32_16x16x32_bf16 v[12:15], v[32:35], v[140:143], v[12:15]
v_mfma_f32_16x16x32_bf16 v[16:19], v[32:35], v[144:147], v[16:19]
v_and_b32 v28, v64, v4
v_and_b32 v29, v64, v5
v_and_b32 v30, v64, v6
v_and_b32 v31, v64, v7
s_waitcnt vmcnt(15)
s_nop 0
v_mfma_f32_16x16x32_bf16 v[8:11], v[28:31], v[148:151], v[8:11]
v_mfma_f32_16x16x32_bf16 v[12:15], v[28:31], v[152:155], v[12:15]
v_mfma_f32_16x16x32_bf16 v[16:19], v[28:31], v[156:159], v[16:19]
v_and_b32 v32, v65, v4
v_and_b32 v33, v65, v5
v_and_b32 v34, v65, v6
v_and_b32 v35, v65, v7
s_waitcnt vmcnt(12)
s_nop 0
v_mfma_f32_16x16x32_bf16 v[8:11], v[32:35], v[160:163], v[8:11]
v_mfma_f32_16x16x32_bf16 v[12:15], v[32:35], v[164:167], v[12:15]
v_mfma_f32_16x16x32_bf16 v[16:19], v[32:35], v[168:171], v[16:19]
v_and_b32 v28, v66, v4
v_and_b32 v29, v66, v5
v_and_b32 v30, v66, v6
v_and_b32 v31, v66, v7
s_waitcnt vmcnt(9)
s_nop 0
v_mfma_f32_16x16x32_bf16 v[8:11], v[28:31], v[172:175], v[8:11]
v_mfma_f32_16x16x32_bf16 v[12:15], v[28:31], v[176:179], v[12:15]
v_mfma_f32_16x16x32_bf16 v[16:19], v[28:31], v[180:183], v[16:19]
v_and_b32 v32, v67, v4
v_and_b32 v33, v67, v5
v_and_b32 v34, v67, v6
v_and_b32 v35, v67, v7
s_waitcnt vmcnt(6)
s_nop 0
v_mfma_f32_16x16x32_bf16 v[8:11], v[32:35], v[184:187], v[8:11]
v_mfma_f32_16x16x32_bf16 v[12:15], v[32:35], v[188:191], v[12:15]
v_mfma_f32_16x16x32_bf16 v[16:19], v[32:35], v[192:195], v[16:19]
v_and_b32 v28, v68, v4
v_and_b32 v29, v68, v5
v_and_b32 v30, v68, v6
v_and_b32 v31, v68, v7
s_waitcnt vmcnt(3)
s_nop 0
v_mfma_f32_16x16x32_bf16 v[8:11], v[28:31], v[196:199], v[8:11]
v_mfma_f32_16x16x32_bf16 v[12:15], v[28:31], v[200:203], v[12:15]
v_mfma_f32_16x16x32_bf16 v[16:19], v[28:31], v[204:207], v[16:19]
v_and_b32 v32, v69, v4
v_and_b32 v33, v69, v5
v_and_b32 v34, v69, v6
v_and_b32 v35, v69, v7
s_waitcnt vmcnt(0)
s_nop 0
v_mfma_f32_16x16x32_bf16 v[8:11], v[32:35], v[208:211], v[8:11]
v_mfma_f32_16x16x32_bf16 v[12:15], v[32:35], v[212:215], v[12:15]
v_mfma_f32_16x16x32_bf16 v[16:19], v[32:35], v[216:219], v[16:19]
s_lshl_b32 s38, s4, 10
s_add_u32 s38, s38, 65536
s_lshl_b32 s91, s5, 13
s_add_u32 s91, s91, 65536
s_add_u32 s92, s91, 4096
s_getreg_b32 s93, hwreg(HW_REG_XCC_ID, 0, 4)
s_lshl_b32 s93, s93, 8
s_xor_b32 s93, s93, s63
s_mov_b32 s90, 0xfffff0ff
v_mov_b32 v43, s93
s_nop 1
s_mov_b64 exec, s[36:37]
ds_write_b128 v20, v[8:11] offset:1280
ds_write_b128 v20, v[12:15] offset:1536
ds_write_b128 v20, v[16:19] offset:1792
s_mov_b64 exec, -1
ds_read2_b32 v[44:45], v21 offset0:0 offset1:192
ds_read2_b32 v[46:47], v21 offset0:1 offset1:193
ds_read2_b32 v[48:49], v21 offset0:2 offset1:194
s_waitcnt lgkmcnt(0)
v_add_f32 v40, v44, v45
v_add_f32 v41, v46, v47
v_add_f32 v42, v48, v49
buffer_store_dwordx4 v[40:43], v22, s[16:19], s38 offen sc1
s_waitcnt vmcnt(0)
s_mov_b32 s38, 1048576
s_mov_b64 s[8:9], -1
s_mov_b64 s[10:11], -1
s_mov_b64 s[12:13], -1
s_mov_b64 s[14:15], -1
s_mov_b64 s[56:57], -1
s_mov_b64 s[58:59], -1
s_mov_b64 s[94:95], -1
s_mov_b64 s[96:97], -1
L_pollq:
s_mov_b64 exec, s[8:9]
buffer_load_dwordx4 v[100:103], v22, s[16:19], s91 offen offset:0 sc1
s_mov_b64 exec, s[10:11]
buffer_load_dwordx4 v[104:107], v22, s[16:19], s91 offen offset:1024 sc1
s_mov_b64 exec, s[12:13]
buffer_load_dwordx4 v[108:111], v22, s[16:19], s91 offen offset:2048 sc1
s_mov_b64 exec, s[14:15]
buffer_load_dwordx4 v[112:115], v22, s[16:19], s91 offen offset:3072 sc1
s_mov_b64 exec, s[56:57]
buffer_load_dwordx4 v[116:119], v22, s[16:19], s92 offen offset:0 sc1
s_mov_b64 exec, s[58:59]
buffer_load_dwordx4 v[120:123], v22, s[16:19], s92 offen offset:1024 sc1
s_mov_b64 exec, s[94:95]
buffer_load_dwordx4 v[124:127], v22, s[16:19], s92 offen offset:2048 sc1
s_mov_b64 exec, s[96:97]
buffer_load_dwordx4 v[128:131], v22, s[16:19], s92 offen offset:3072 sc1
s_mov_b64 exec, -1
s_waitcnt vmcnt(7)
v_xor_b32 v48, s93, v103
v_and_b32 v45, s90, v48
v_cmp_ne_u32 s[8:9], 0, v45
s_waitcnt vmcnt(6)
v_xor_b32 v49, s93, v107
v_and_b32 v45, s90, v49
v_cmp_ne_u32 s[10:11], 0, v45
s_waitcnt vmcnt(5)
v_xor_b32 v50, s93, v111
v_and_b32 v45, s90, v50
v_cmp_ne_u32 s[12:13], 0, v45
s_waitcnt vmcnt(4)
v_xor_b32 v51, s93, v115
v_and_b32 v45, s90, v51
v_cmp_ne_u32 s[14:15], 0, v45
s_waitcnt vmcnt(3)
v_xor_b32 v52, s93, v119
v_and_b32 v45, s90, v52
v_cmp_ne_u32 s[56:57], 0, v45
s_waitcnt vmcnt(2)
v_xor_b32 v53, s93, v123
v_and_b32 v45, s90, v53
v_cmp_ne_u32 s[58:59], 0, v45
s_waitcnt vmcnt(1)
v_xor_b32 v54, s93, v127
v_and_b32 v45, s90, v54
v_cmp_ne_u32 s[94:95], 0, v45
s_waitcnt vmcnt(0)
v_xor_b32 v55, s93, v131
v_and_b32 v45, s90, v55
v_cmp_ne_u32 s[96:97], 0, v45
s_or_b64 vcc, s[8:9], s[10:11]
s_or_b64 vcc, vcc, s[12:13]
s_or_b64 vcc, vcc, s[14:15]
s_or_b64 vcc, vcc, s[56:57]
s_or_b64 vcc, vcc, s[58:59]
s_or_b64 vcc, vcc, s[94:95]
s_or_b64 vcc, vcc, s[96:97]
s_cbranch_scc0 L_gotq
s_sleep 4
s_sub_u32 s38, s38, 1
s_cbranch_scc0 L_pollq
L_gotq:
v_add_f32 v100, v100, v104
v_add_f32 v101, v101, v105
v_add_f32 v102, v102, v106
v_add_f32 v100, v100, v108
v_add_f32 v101, v101, v109
v_add_f32 v102, v102, v110
v_add_f32 v100, v100, v112
v_add_f32 v101, v101, v113
v_add_f32 v102, v102, v114
v_add_f32 v100, v100, v116
v_add_f32 v101, v101, v117
v_add_f32 v102, v102, v118
v_add_f32 v100, v100, v120
v_add_f32 v101, v101, v121
v_add_f32 v102, v102, v122
v_add_f32 v100, v100, v124
v_add_f32 v101, v101, v125
v_add_f32 v102, v102, v126
v_add_f32 v100, v100, v128
v_add_f32 v101, v101, v129
v_add_f32 v102, v102, v130
v_cvt_pk_bf16_f32 v44, v100, v101
v_cvt_pk_bf16_f32 v45, v102, v102
v_mul_u32_u24 v23, 6, v0
ds_write_b16 v23, v44 offset:2816
ds_write_b16_d16_hi v23, v44 offset:2818
ds_write_b16 v23, v45 offset:2820
v_or3_b32 v48, v48, v49, v50
v_or3_b32 v51, v51, v52, v53
v_or3_b32 v48, v48, v54, v55
v_or_b32 v48, v48, v51
v_cmp_ne_u32 vcc, 0, v48
s_cmp_eq_u64 vcc, 0
s_cselect_b32 s90, 1, 0
v_mov_b32 v49, s90
v_mov_b32 v50, 0
ds_write_b32 v50, v49 offset:15936
v_lshlrev_b32 v70, 3, v0
v_mov_b32 v72, s98
v_mov_b32 v73, 0x1000
v_mov_b32 v71, 0
s_mov_b64 exec, 15
ds_write_b64 v70, v[72:73] offset:15904
s_mov_b64 exec, -1
v_lshlrev_b32 v74, 4, v0
s_lshl_b32 s99, s2, 4
s_add_u32 s99, s99, 917504
s_mov_b32 s56, 917504
s_waitcnt lgkmcnt(0)
s_barrier
s_setprio 0
ds_read_b128 v[76:79], v71 offset:15872
ds_read_b128 v[80:83], v71 offset:15888
s_lshl_b32 s57, s98, 2
s_waitcnt lgkmcnt(0)
v_readfirstlane_b32 s58, v77
v_add3_u32 v85, v76, v78, v80
v_add_u32 v85, v85, v82
v_subrev_u32 v85, s57, v85
v_add3_u32 v86, v77, v79, v81
v_add_u32 v86, v86, v83
v_mov_b32 v84, s98
v_cvt_f32_u32 v85, v85
v_cvt_f32_u32 v86, v86
v_mov_b32 v87, s63
s_cmp_ge_u32 s2, 16
s_cbranch_scc1 L_nopub0
s_mov_b64 exec, 1
buffer_store_dwordx4 v[84:87], v71, s[16:19], s99 offen sc1
s_mov_b64 exec, -1
L_nopub0:
s_add_u32 s99, s99, 1024
v_mul_u32_u24 v2, 3072, v36
v_add_u32 v2, v2, v38
v_mov_b32 v24, 0x40000000
v_cmp_lt_u32 vcc, 5, v37
s_nop 1
v_cndmask_b32 v2, v2, v24, vcc
s_mul_i32 s7, s6, 245760
s_mul_i32 s38, s5, 96
s_add_u32 s7, s7, s38
buffer_load_dwordx4 v[100:103], v2, s[24:27], s7 offen nt
buffer_load_dwordx4 v[104:107], v2, s[28:31], s7 offen nt
s_add_u32 s7, s7, 24576
buffer_load_dwordx4 v[108:111], v2, s[24:27], s7 offen nt
buffer_load_dwordx4 v[112:115], v2, s[28:31], s7 offen nt
s_add_u32 s7, s7, 24576
buffer_load_dwordx4 v[116:119], v2, s[24:27], s7 offen nt
buffer_load_dwordx4 v[120:123], v2, s[28:31], s7 offen nt
s_add_u32 s7, s7, 24576
buffer_load_dwordx4 v[124:127], v2, s[24:27], s7 offen nt
buffer_load_dwordx4 v[128:131], v2, s[28:31], s7 offen nt
v_and_b32 v28, v60, v4
v_and_b32 v29, v60, v5
v_and_b32 v30, v60, v6
v_and_b32 v31, v60, v7
s_waitcnt vmcnt(6)
s_add_u32 s7, s7, 24576
buffer_load_dwordx4 v[132:135], v2, s[24:27], s7 offen nt
buffer_load_dwordx4 v[136:139], v2, s[28:31], s7 offen nt
v_mfma_f32_16x16x32_bf16 v[8:11], v[28:31], v[100:103], 0
v_mfma_f32_16x16x32_bf16 v[12:15], v[28:31], v[104:107], 0
v_and_b32 v32, v61, v4
v_and_b32 v33, v61, v5
v_and_b32 v34, v61, v6
v_and_b32 v35, v61, v7
s_waitcnt vmcnt(6)
s_add_u32 s7, s7, 24576
buffer_load_dwordx4 v[140:143], v2, s[24:27], s7 offen nt
buffer_load_dwordx4 v[144:147], v2, s[28:31], s7 offen nt
v_mfma_f32_16x16x32_bf16 v[8:11], v[32:35], v[108:111], v[8:11]
v_mfma_f32_16x16x32_bf16 v[12:15], v[32:35], v[112:115], v[12:15]
v_and_b32 v28, v62, v4
v_and_b32 v29, v62, v5
v_and_b32 v30, v62, v6
v_and_b32 v31, v62, v7
s_waitcnt vmcnt(6)
s_add_u32 s7, s7, 24576
buffer_load_dwordx4 v[148:151], v2, s[24:27], s7 offen nt
buffer_load_dwordx4 v[152:155], v2, s[28:31], s7 offen nt
v_mfma_f32_16x16x32_bf16 v[8:11], v[28:31], v[116:119], v[8:11]
v_mfma_f32_16x16x32_bf16 v[12:15], v[28:31], v[120:123], v[12:15]
v_and_b32 v32, v63, v4
v_and_b32 v33, v63, v5
v_and_b32 v34, v63, v6
v_and_b32 v35, v63, v7
s_waitcnt vmcnt(6)
s_add_u32 s7, s7, 24576
buffer_load_dwordx4 v[156:159], v2, s[24:27], s7 offen nt
buffer_load_dwordx4 v[160:163], v2, s[28:31], s7 offen nt
v_mfma_f32_16x16x32_bf16 v[8:11], v[32:35], v[124:127], v[8:11]
v_mfma_f32_16x16x32_bf16 v[12:15], v[32:35], v[128:131], v[12:15]
v_and_b32 v28, v64, v4
v_and_b32 v29, v64, v5
v_and_b32 v30, v64, v6
v_and_b32 v31, v64, v7
s_waitcnt vmcnt(6)
s_add_u32 s7, s7, 24576
buffer_load_dwordx4 v[164:167], v2, s[24:27], s7 offen nt
buffer_load_dwordx4 v[168:171], v2, s[28:31], s7 offen nt
v_mfma_f32_16x16x32_bf16 v[8:11], v[28:31], v[132:135], v[8:11]
v_mfma_f32_16x16x32_bf16 v[12:15], v[28:31], v[136:139], v[12:15]
v_and_b32 v32, v65, v4
v_and_b32 v33, v65, v5
v_and_b32 v34, v65, v6
v_and_b32 v35, v65, v7
s_waitcnt vmcnt(6)
s_add_u32 s7, s7, 24576
buffer_load_dwordx4 v[172:175], v2, s[24:27], s7 offen nt
buffer_load_dwordx4 v[176:179], v2, s[28:31], s7 offen nt
v_mfma_f32_16x16x32_bf16 v[8:11], v[32:35], v[140:143], v[8:11]
v_mfma_f32_16x16x32_bf16 v[12:15], v[32:35], v[144:147], v[12:15]
v_and_b32 v28, v66, v4
v_and_b32 v29, v66, v5
v_and_b32 v30, v66, v6
v_and_b32 v31, v66, v7
s_waitcnt vmcnt(6)
s_nop 0
v_mfma_f32_16x16x32_bf16 v[8:11], v[28:31], v[148:151], v[8:11]
v_mfma_f32_16x16x32_bf16 v[12:15], v[28:31], v[152:155], v[12:15]
v_and_b32 v32, v67, v4
v_and_b32 v33, v67, v5
v_and_b32 v34, v67, v6
v_and_b32 v35, v67, v7
s_waitcnt vmcnt(4)
s_nop 0
v_mfma_f32_16x16x32_bf16 v[8:11], v[32:35], v[156:159], v[8:11]
v_mfma_f32_16x16x32_bf16 v[12:15], v[32:35], v[160:163], v[12:15]
v_and_b32 v28, v68, v4
v_and_b32 v29, v68, v5
v_and_b32 v30, v68, v6
v_and_b32 v31, v68, v7
s_waitcnt vmcnt(2)
s_nop 0
v_mfma_f32_16x16x32_bf16 v[8:11], v[28:31], v[164:167], v[8:11]
v_mfma_f32_16x16x32_bf16 v[12:15], v[28:31], v[168:171], v[12:15]
v_and_b32 v32, v69, v4
v_and_b32 v33, v69, v5
v_and_b32 v34, v69, v6
v_and_b32 v35, v69, v7
s_waitcnt vmcnt(0)
s_nop 0
v_mfma_f32_16x16x32_bf16 v[8:11], v[32:35], v[172:175], v[8:11]
v_mfma_f32_16x16x32_bf16 v[12:15], v[32:35], v[176:179], v[12:15]
v_mul_u32_u24 v2, 1280, v36
v_add_u32 v2, v2, v38
v_cmp_lt_u32 vcc, 5, v36
s_nop 1
v_cndmask_b32 v2, v2, v24, vcc
s_mul_i32 s7, s4, 7680
buffer_load_dwordx4 v[200:203], v2, s[32:35], s7 offen offset:0 nt
buffer_load_dwordx4 v[204:207], v2, s[32:35], s7 offen offset:128 nt
buffer_load_dwordx4 v[208:211], v2, s[32:35], s7 offen offset:256 nt
buffer_load_dwordx4 v[212:215], v2, s[32:35], s7 offen offset:384 nt
buffer_load_dwordx4 v[216:219], v2, s[32:35], s7 offen offset:512 nt
buffer_load_dwordx4 v[220:223], v2, s[32:35], s7 offen offset:640 nt
buffer_load_dwordx4 v[224:227], v2, s[32:35], s7 offen offset:768 nt
buffer_load_dwordx4 v[228:231], v2, s[32:35], s7 offen offset:896 nt
buffer_load_dwordx4 v[232:235], v2, s[32:35], s7 offen offset:1024 nt
buffer_load_dwordx4 v[236:239], v2, s[32:35], s7 offen offset:1152 nt
s_mov_b64 exec, s[36:37]
ds_write_b128 v20, v[8:11] offset:1280
ds_write_b128 v20, v[12:15] offset:1536
s_mov_b64 exec, -1
v_mul_u32_u24 v21, 6, v36
v_add_u32 v21, v21, v37
v_lshlrev_b32 v21, 2, v21
v_add_u32 v21, 1280, v21
v_add_u32 v23, 256, v21
ds_read2_b32 v[44:45], v21 offset0:0 offset1:192
ds_read2_b32 v[46:47], v23 offset0:0 offset1:192
v_mul_u32_u24 v25, 48, v36
v_lshlrev_b32 v26, 3, v37
v_add_u32 v25, v25, v26
s_mul_i32 s38, s4, 384
s_add_u32 s38, s38, 327680
s_and_b32 s94, s63, 0xff
v_mov_b32 v27, s94
s_mul_i32 s94, s94, 0x01010101
s_mov_b32 s95, 0xffffff00
s_mov_b32 s100, 0x0c0c0400
s_mov_b32 s101, 0x0c040100
s_mov_b32 s59, 0x04020100
s_waitcnt lgkmcnt(0)
v_add_f32 v40, v44, v45
v_add_f32 v41, v46, v47
v_and_or_b32 v40, v40, s95, v27
v_and_or_b32 v41, v41, s95, v27
v_mul_u32_u24 v22, 384, v37
v_lshrrev_b32 v26, 1, v36
v_lshlrev_b32 v26, 4, v26
v_add_u32 v22, v22, v26
v_mov_b32_dpp v42, v40 quad_perm:[1,0,3,2] row_mask:0xf bank_mask:0xf
v_mov_b32_dpp v43, v41 quad_perm:[1,0,3,2] row_mask:0xf bank_mask:0xf
s_mov_b32 exec_lo, 0x15151515
s_mov_b32 exec_hi, 0x15151515
s_cmp_eq_u32 s90, 1
s_cbranch_scc1 L_floc
buffer_store_dwordx4 v[40:43], v25, s[16:19], s38 offen sc1
s_branch L_fdone
L_floc:
buffer_store_dwordx4 v[40:43], v25, s[16:19], s38 offen
L_fdone:
s_mov_b64 exec, -1
v_lshlrev_b32 v23, 10, v36
v_add_u32 v23, v23, v38
s_mul_i32 s91, s5, 3072
s_mul_i32 s38, s6, 48
s_add_u32 s91, s91, s38
s_add_u32 s91, s91, 327680
v_mov_b32 v44, 0
v_mov_b32 v45, 0
v_mov_b32 v46, 0
v_mov_b32 v47, 0
s_waitcnt vmcnt(0)
v_mov_b32 v91, 0
s_bfm_b64 exec, 16, 0
buffer_load_dwordx4 v[88:91], v74, s[16:19], s56 offen sc1
s_mov_b64 exec, -1
s_add_u32 s56, s56, 1024
s_waitcnt vmcnt(0)
s_bfm_b64 exec, 16, 0
v_cmp_eq_u32 vcc, s63, v91
s_mov_b64 exec, -1
v_subrev_u32 v88, s98, v88
v_cvt_f32_i32 v88, v88
s_cbranch_vccz L_noupd1
v_cndmask_b32 v88, 0, v88, vcc
v_cndmask_b32 v89, 0, v89, vcc
v_cndmask_b32 v90, 0, v90, vcc
v_cndmask_b32 v91, 0, 1.0, vcc
s_nop 0
v_add_f32_dpp v88, v88, v88 quad_perm:[1,0,3,2] row_mask:0xf bank_mask:0xf
v_add_f32_dpp v89, v89, v89 quad_perm:[1,0,3,2] row_mask:0xf bank_mask:0xf
v_add_f32_dpp v90, v90, v90 quad_perm:[1,0,3,2] row_mask:0xf bank_mask:0xf
v_add_f32_dpp v91, v91, v91 quad_perm:[1,0,3,2] row_mask:0xf bank_mask:0xf
v_add_f32_dpp v88, v88, v88 quad_perm:[2,3,0,1] row_mask:0xf bank_mask:0xf
v_add_f32_dpp v89, v89, v89 quad_perm:[2,3,0,1] row_mask:0xf bank_mask:0xf
v_add_f32_dpp v90, v90, v90 quad_perm:[2,3,0,1] row_mask:0xf bank_mask:0xf
v_add_f32_dpp v91, v91, v91 quad_perm:[2,3,0,1] row_mask:0xf bank_mask:0xf
v_add_f32_dpp v88, v88, v88 row_half_mirror row_mask:0xf bank_mask:0xf
v_add_f32_dpp v89, v89, v89 row_half_mirror row_mask:0xf bank_mask:0xf
v_add_f32_dpp v90, v90, v90 row_half_mirror row_mask:0xf bank_mask:0xf
v_add_f32_dpp v91, v91, v91 row_half_mirror row_mask:0xf bank_mask:0xf
v_add_f32_dpp v88, v88, v88 row_ror:8 row_mask:0xf bank_mask:0xf
v_add_f32_dpp v89, v89, v89 row_ror:8 row_mask:0xf bank_mask:0xf
v_add_f32_dpp v90, v90, v90 row_ror:8 row_mask:0xf bank_mask:0xf
v_add_f32_dpp v91, v91, v91 row_ror:8 row_mask:0xf bank_mask:0xf
v_mov_b32 v92, v88
v_mov_b32 v93, v89
v_mov_b32 v94, v90
v_mov_b32 v95, v91
s_nop 1
v_permlane16_swap_b32 v92, v88
v_permlane16_swap_b32 v93, v89
v_permlane16_swap_b32 v94, v90
v_permlane16_swap_b32 v95, v91
v_add_f32 v88, v92, v88
v_add_f32 v89, v93, v89
v_add_f32 v90, v94, v90
v_add_f32 v91, v95, v91
v_mov_b32 v92, v88
v_mov_b32 v93, v89
v_mov_b32 v94, v90
v_mov_b32 v95, v91
s_nop 1
v_permlane32_swap_b32 v92, v88
v_permlane32_swap_b32 v93, v89
v_permlane32_swap_b32 v94, v90
v_permlane32_swap_b32 v95, v91
v_add_f32 v88, v92, v88
v_add_f32 v89, v93, v89
v_add_f32 v90, v94, v90
v_add_f32 v91, v95, v91
v_rcp_f32 v90, v90
v_rcp_f32 v91, v91
v_mul_f32 v89, 0x45800000, v89
v_mul_f32 v89, v89, v90
v_mul_f32 v88, v88, v91
v_add_f32 v88, 0x40a00000, v88
v_cvt_i32_f32 v88, v88
v_cvt_u32_f32 v89, v89
v_add_u32 v88, s98, v88
s_mov_b64 exec, 15
ds_write_b64 v70, v[88:89] offset:15904
s_mov_b64 exec, -1
L_noupd1:
s_mov_b32 s38, 1048576
s_mov_b32 exec_hi, 0xffff
L_pollf:
buffer_load_dwordx4 v[44:47], v22, s[16:19], s91 offen sc1
s_waitcnt vmcnt(0)
v_perm_b32 v48, v45, v44, s100
v_perm_b32 v48, v46, v48, s101
v_perm_b32 v48, v47, v48, s59
v_cmp_ne_u32 vcc, s94, v48
s_mov_b64 exec, vcc
s_cbranch_execz L_gotf
s_sleep 32
s_sub_u32 s38, s38, 1
s_cbranch_scc0 L_pollf
L_gotf:
s_mov_b64 exec, -1
s_mov_b32 vcc_lo, 0xff00ff00
s_mov_b32 vcc_hi, 0xff00ff00
v_cndmask_b32 v44, v44, v46, vcc
v_cndmask_b32 v45, v45, v47, vcc
v_and_b32 v44, s95, v44
v_and_b32 v45, s95, v45
s_nop 0
s_nop 0
v_add_f32_dpp v44, v44, v44 quad_perm:[1,0,3,2] row_mask:0xf bank_mask:0xf
v_add_f32_dpp v45, v45, v45 quad_perm:[1,0,3,2] row_mask:0xf bank_mask:0xf
s_nop 0
v_add_f32_dpp v44, v44, v44 quad_perm:[2,3,0,1] row_mask:0xf bank_mask:0xf
v_add_f32_dpp v45, v45, v45 quad_perm:[2,3,0,1] row_mask:0xf bank_mask:0xf
s_nop 0
v_add_f32_dpp v44, v44, v44 row_half_mirror row_mask:0xf bank_mask:0xf
v_add_f32_dpp v45, v45, v45 row_half_mirror row_mask:0xf bank_mask:0xf
v_cvt_pk_bf16_f32 v44, v44, v44
v_and_b32 v44, s60, v44
v_cvt_pk_bf16_f32 v45, v45, v45
v_and_b32 v45, s60, v45
v_max_f32 v44, 0, v44
v_mul_f32 v44, v44, v45
v_cvt_pk_bf16_f32 v44, v44, v44
v_and_b32 v28, v44, v4
v_and_b32 v29, v44, v5
v_and_b32 v30, v44, v6
v_and_b32 v31, v44, v7
s_nop 1
v_mfma_f32_16x16x32_bf16 v[100:103], v[28:31], v[200:203], 0
v_mfma_f32_16x16x32_bf16 v[104:107], v[28:31], v[204:207], 0
v_mfma_f32_16x16x32_bf16 v[108:111], v[28:31], v[208:211], 0
v_mfma_f32_16x16x32_bf16 v[112:115], v[28:31], v[212:215], 0
v_mfma_f32_16x16x32_bf16 v[116:119], v[28:31], v[216:219], 0
v_mfma_f32_16x16x32_bf16 v[120:123], v[28:31], v[220:223], 0
v_mfma_f32_16x16x32_bf16 v[124:127], v[28:31], v[224:227], 0
v_mfma_f32_16x16x32_bf16 v[128:131], v[28:31], v[228:231], 0
v_mfma_f32_16x16x32_bf16 v[132:135], v[28:31], v[232:235], 0
v_mfma_f32_16x16x32_bf16 v[136:139], v[28:31], v[236:239], 0
v_lshrrev_b32 v20, 5, v0
v_mul_u32_u24 v20, 2560, v20
v_lshlrev_b32 v21, 5, v37
v_add_u32 v20, v20, v21
v_and_b32 v21, 16, v0
v_add_u32 v20, v20, v21
s_nop 3
s_mov_b64 exec, s[36:37]
ds_write_b128 v20, v[100:103] offset:3200
ds_write_b128 v20, v[104:107] offset:3456
ds_write_b128 v20, v[108:111] offset:3712
ds_write_b128 v20, v[112:115] offset:3968
ds_write_b128 v20, v[116:119] offset:4224
ds_write_b128 v20, v[120:123] offset:4480
ds_write_b128 v20, v[124:127] offset:4736
ds_write_b128 v20, v[128:131] offset:4992
ds_write_b128 v20, v[132:135] offset:5248
ds_write_b128 v20, v[136:139] offset:5504
s_mov_b64 exec, -1
s_waitcnt lgkmcnt(0)
L_noffn:
v_mov_b32 v60, 0
v_mov_b32 v61, 0
v_mov_b32 v62, 0
v_mov_b32 v63, 0
s_mov_b32 s92, 0x3e800000
v_cmp_gt_u32 vcc, 16, v0
v_mov_b32 v66, 0x43960000
v_cndmask_b32 v67, 0, v66, vcc
s_mov_b32 s59, 1223
s_mov_b32 s38, 1048576
L_cw2:
s_sleep 8
ds_read_b32 v77, v71 offset:15876
s_waitcnt lgkmcnt(0)
v_cmp_le_u32 vcc, s59, v77
s_cbranch_vccnz L_cg2
s_sub_u32 s38, s38, 1
s_cbranch_scc0 L_cw2
L_cg2:
ds_read_b128 v[76:79], v71 offset:15872
ds_read_b128 v[80:83], v71 offset:15888
s_lshl_b32 s57, s98, 2
s_waitcnt lgkmcnt(0)
v_readfirstlane_b32 s58, v77
v_add3_u32 v85, v76, v78, v80
v_add_u32 v85, v85, v82
v_subrev_u32 v85, s57, v85
v_add3_u32 v86, v77, v79, v81
v_add_u32 v86, v86, v83
v_mov_b32 v84, s98
v_cvt_f32_u32 v85, v85
v_cvt_f32_u32 v86, v86
v_mov_b32 v87, s63
s_cmp_ge_u32 s2, 16
s_cbranch_scc1 L_nopub3
s_mov_b64 exec, 1
buffer_store_dwordx4 v[84:87], v71, s[16:19], s99 offen sc1
s_mov_b64 exec, -1
L_nopub3:
s_add_u32 s99, s99, 1024
s_mov_b32 s59, 1588
s_mov_b32 s38, 1048576
L_cw4:
s_sleep 8
ds_read_b32 v77, v71 offset:15876
s_waitcnt lgkmcnt(0)
v_cmp_le_u32 vcc, s59, v77
s_cbranch_vccnz L_cg4
s_sub_u32 s38, s38, 1
s_cbranch_scc0 L_cw4
L_cg4:
v_mov_b32 v91, 0
s_bfm_b64 exec, 16, 0
buffer_load_dwordx4 v[88:91], v74, s[16:19], s56 offen sc1
s_mov_b64 exec, -1
s_add_u32 s56, s56, 1024
s_waitcnt vmcnt(0)
s_bfm_b64 exec, 16, 0
v_cmp_eq_u32 vcc, s63, v91
s_mov_b64 exec, -1
v_subrev_u32 v88, s98, v88
v_cvt_f32_i32 v88, v88
s_cbranch_vccz L_noupd5
v_cndmask_b32 v88, 0, v88, vcc
v_cndmask_b32 v89, 0, v89, vcc
v_cndmask_b32 v90, 0, v90, vcc
v_cndmask_b32 v91, 0, 1.0, vcc
s_nop 0
v_add_f32_dpp v88, v88, v88 quad_perm:[1,0,3,2] row_mask:0xf bank_mask:0xf
v_add_f32_dpp v89, v89, v89 quad_perm:[1,0,3,2] row_mask:0xf bank_mask:0xf
v_add_f32_dpp v90, v90, v90 quad_perm:[1,0,3,2] row_mask:0xf bank_mask:0xf
v_add_f32_dpp v91, v91, v91 quad_perm:[1,0,3,2] row_mask:0xf bank_mask:0xf
v_add_f32_dpp v88, v88, v88 quad_perm:[2,3,0,1] row_mask:0xf bank_mask:0xf
v_add_f32_dpp v89, v89, v89 quad_perm:[2,3,0,1] row_mask:0xf bank_mask:0xf
v_add_f32_dpp v90, v90, v90 quad_perm:[2,3,0,1] row_mask:0xf bank_mask:0xf
v_add_f32_dpp v91, v91, v91 quad_perm:[2,3,0,1] row_mask:0xf bank_mask:0xf
v_add_f32_dpp v88, v88, v88 row_half_mirror row_mask:0xf bank_mask:0xf
v_add_f32_dpp v89, v89, v89 row_half_mirror row_mask:0xf bank_mask:0xf
v_add_f32_dpp v90, v90, v90 row_half_mirror row_mask:0xf bank_mask:0xf
v_add_f32_dpp v91, v91, v91 row_half_mirror row_mask:0xf bank_mask:0xf
v_add_f32_dpp v88, v88, v88 row_ror:8 row_mask:0xf bank_mask:0xf
v_add_f32_dpp v89, v89, v89 row_ror:8 row_mask:0xf bank_mask:0xf
v_add_f32_dpp v90, v90, v90 row_ror:8 row_mask:0xf bank_mask:0xf
v_add_f32_dpp v91, v91, v91 row_ror:8 row_mask:0xf bank_mask:0xf
v_mov_b32 v92, v88
v_mov_b32 v93, v89
v_mov_b32 v94, v90
v_mov_b32 v95, v91
s_nop 1
v_permlane16_swap_b32 v92, v88
v_permlane16_swap_b32 v93, v89
v_permlane16_swap_b32 v94, v90
v_permlane16_swap_b32 v95, v91
v_add_f32 v88, v92, v88
v_add_f32 v89, v93, v89
v_add_f32 v90, v94, v90
v_add_f32 v91, v95, v91
v_mov_b32 v92, v88
v_mov_b32 v93, v89
v_mov_b32 v94, v90
v_mov_b32 v95, v91
s_nop 1
v_permlane32_swap_b32 v92, v88
v_permlane32_swap_b32 v93, v89
v_permlane32_swap_b32 v94, v90
v_permlane32_swap_b32 v95, v91
v_add_f32 v88, v92, v88
v_add_f32 v89, v93, v89
v_add_f32 v90, v94, v90
v_add_f32 v91, v95, v91
v_rcp_f32 v91, v91
v_fmac_f32 v88, 0x3e800000, v89
v_mul_f32 v90, 0x3e800000, v90
v_mul_f32 v88, v88, v91
v_mul_f32 v90, v90, v91
v_sub_f32 v92, v88, v60
v_sub_f32 v93, v90, v61
v_rcp_f32 v93, v93
v_mov_b32 v62, v60
v_mov_b32 v63, v61
v_mov_b32 v60, v88
v_mov_b32 v61, v90
v_mul_f32 v92, v92, v93
v_max_f32 v92, 0x3f4ccccd, v92
v_min_f32 v92, 0x3fc00000, v92
v_fma_f32 v88, -v92, v90, v88
v_mul_f32 v89, 0x45800000, v92
v_add_f32 v88, 0x40a00000, v88
v_cvt_i32_f32 v88, v88
v_cvt_u32_f32 v89, v89
v_add_u32 v88, s98, v88
s_mov_b64 exec, 15
ds_write_b64 v70, v[88:89] offset:15904
s_mov_b64 exec, -1
L_noupd5:
s_mov_b32 s59, 1912
s_mov_b32 s38, 1048576
L_cw6:
s_sleep 8
ds_read_b32 v77, v71 offset:15876
s_waitcnt lgkmcnt(0)
v_cmp_le_u32 vcc, s59, v77
s_cbranch_vccnz L_cg6
s_sub_u32 s38, s38, 1
s_cbranch_scc0 L_cw6
L_cg6:
ds_read_b128 v[76:79], v71 offset:15872
ds_read_b128 v[80:83], v71 offset:15888
s_lshl_b32 s57, s98, 2
s_waitcnt lgkmcnt(0)
v_readfirstlane_b32 s58, v77
v_add3_u32 v85, v76, v78, v80
v_add_u32 v85, v85, v82
v_subrev_u32 v85, s57, v85
v_add3_u32 v86, v77, v79, v81
v_add_u32 v86, v86, v83
v_mov_b32 v84, s98
v_cvt_f32_u32 v85, v85
v_cvt_f32_u32 v86, v86
v_mov_b32 v87, s63
s_cmp_ge_u32 s2, 16
s_cbranch_scc1 L_nopub7
s_mov_b64 exec, 1
buffer_store_dwordx4 v[84:87], v71, s[16:19], s99 offen sc1
s_mov_b64 exec, -1
L_nopub7:
s_add_u32 s99, s99, 1024
s_mov_b32 s59, 2236
s_mov_b32 s38, 1048576
L_cw8:
s_sleep 8
ds_read_b32 v77, v71 offset:15876
s_waitcnt lgkmcnt(0)
v_cmp_le_u32 vcc, s59, v77
s_cbranch_vccnz L_cg8
s_sub_u32 s38, s38, 1
s_cbranch_scc0 L_cw8
L_cg8:
v_mov_b32 v91, 0
s_bfm_b64 exec, 16, 0
buffer_load_dwordx4 v[88:91], v74, s[16:19], s56 offen sc1
s_mov_b64 exec, -1
s_add_u32 s56, s56, 1024
s_waitcnt vmcnt(0)
s_bfm_b64 exec, 16, 0
v_cmp_eq_u32 vcc, s63, v91
s_mov_b64 exec, -1
v_subrev_u32 v88, s98, v88
v_cvt_f32_i32 v88, v88
s_cbranch_vccz L_noupd9
v_cndmask_b32 v88, 0, v88, vcc
v_cndmask_b32 v89, 0, v89, vcc
v_cndmask_b32 v90, 0, v90, vcc
v_cndmask_b32 v91, 0, 1.0, vcc
s_nop 0
v_add_f32_dpp v88, v88, v88 quad_perm:[1,0,3,2] row_mask:0xf bank_mask:0xf
v_add_f32_dpp v89, v89, v89 quad_perm:[1,0,3,2] row_mask:0xf bank_mask:0xf
v_add_f32_dpp v90, v90, v90 quad_perm:[1,0,3,2] row_mask:0xf bank_mask:0xf
v_add_f32_dpp v91, v91, v91 quad_perm:[1,0,3,2] row_mask:0xf bank_mask:0xf
v_add_f32_dpp v88, v88, v88 quad_perm:[2,3,0,1] row_mask:0xf bank_mask:0xf
v_add_f32_dpp v89, v89, v89 quad_perm:[2,3,0,1] row_mask:0xf bank_mask:0xf
v_add_f32_dpp v90, v90, v90 quad_perm:[2,3,0,1] row_mask:0xf bank_mask:0xf
v_add_f32_dpp v91, v91, v91 quad_perm:[2,3,0,1] row_mask:0xf bank_mask:0xf
v_add_f32_dpp v88, v88, v88 row_half_mirror row_mask:0xf bank_mask:0xf
v_add_f32_dpp v89, v89, v89 row_half_mirror row_mask:0xf bank_mask:0xf
v_add_f32_dpp v90, v90, v90 row_half_mirror row_mask:0xf bank_mask:0xf
v_add_f32_dpp v91, v91, v91 row_half_mirror row_mask:0xf bank_mask:0xf
v_add_f32_dpp v88, v88, v88 row_ror:8 row_mask:0xf bank_mask:0xf
v_add_f32_dpp v89, v89, v89 row_ror:8 row_mask:0xf bank_mask:0xf
v_add_f32_dpp v90, v90, v90 row_ror:8 row_mask:0xf bank_mask:0xf
v_add_f32_dpp v91, v91, v91 row_ror:8 row_mask:0xf bank_mask:0xf
v_mov_b32 v92, v88
v_mov_b32 v93, v89
v_mov_b32 v94, v90
v_mov_b32 v95, v91
s_nop 1
v_permlane16_swap_b32 v92, v88
v_permlane16_swap_b32 v93, v89
v_permlane16_swap_b32 v94, v90
v_permlane16_swap_b32 v95, v91
v_add_f32 v88, v92, v88
v_add_f32 v89, v93, v89
v_add_f32 v90, v94, v90
v_add_f32 v91, v95, v91
v_mov_b32 v92, v88
v_mov_b32 v93, v89
v_mov_b32 v94, v90
v_mov_b32 v95, v91
s_nop 1
v_permlane32_swap_b32 v92, v88
v_permlane32_swap_b32 v93, v89
v_permlane32_swap_b32 v94, v90
v_permlane32_swap_b32 v95, v91
v_add_f32 v88, v92, v88
v_add_f32 v89, v93, v89
v_add_f32 v90, v94, v90
v_add_f32 v91, v95, v91
v_rcp_f32 v91, v91
v_fmac_f32 v88, 0x3e800000, v89
v_mul_f32 v90, 0x3e800000, v90
v_mul_f32 v88, v88, v91
v_mul_f32 v90, v90, v91
v_sub_f32 v92, v88, v60
v_sub_f32 v93, v90, v61
v_rcp_f32 v93, v93
v_mov_b32 v62, v60
v_mov_b32 v63, v61
v_mov_b32 v60, v88
v_mov_b32 v61, v90
v_mul_f32 v92, v92, v93
v_max_f32 v92, 0x3f4ccccd, v92
v_min_f32 v92, 0x3fc00000, v92
v_fma_f32 v88, -v92, v90, v88
v_mul_f32 v89, 0x45800000, v92
v_add_f32 v88, 0x40a00000, v88
v_cvt_i32_f32 v88, v88
v_cvt_u32_f32 v89, v89
v_add_u32 v88, s98, v88
s_mov_b64 exec, 15
ds_write_b64 v70, v[88:89] offset:15904
s_mov_b64 exec, -1
L_noupd9:
s_mov_b32 s59, 2560
s_mov_b32 s38, 1048576
L_cw10:
s_sleep 8
ds_read_b32 v77, v71 offset:15876
s_waitcnt lgkmcnt(0)
v_cmp_le_u32 vcc, s59, v77
s_cbranch_vccnz L_cg10
s_sub_u32 s38, s38, 1
s_cbranch_scc0 L_cw10
L_cg10:
ds_read_b128 v[76:79], v71 offset:15872
ds_read_b128 v[80:83], v71 offset:15888
s_lshl_b32 s57, s98, 2
s_waitcnt lgkmcnt(0)
v_readfirstlane_b32 s58, v77
v_add3_u32 v85, v76, v78, v80
v_add_u32 v85, v85, v82
v_subrev_u32 v85, s57, v85
v_add3_u32 v86, v77, v79, v81
v_add_u32 v86, v86, v83
v_mov_b32 v84, s98
v_cvt_f32_u32 v85, v85
v_cvt_f32_u32 v86, v86
v_mov_b32 v87, s63
s_cmp_ge_u32 s2, 16
s_cbranch_scc1 L_nopub11
s_mov_b64 exec, 1
buffer_store_dwordx4 v[84:87], v71, s[16:19], s99 offen sc1
s_mov_b64 exec, -1
L_nopub11:
s_add_u32 s99, s99, 1024
s_mov_b32 s59, 2884
s_mov_b32 s38, 1048576
L_cw12:
s_sleep 8
ds_read_b32 v77, v71 offset:15876
s_waitcnt lgkmcnt(0)
v_cmp_le_u32 vcc, s59, v77
s_cbranch_vccnz L_cg12
s_sub_u32 s38, s38, 1
s_cbranch_scc0 L_cw12
L_cg12:
v_mov_b32 v91, 0
s_bfm_b64 exec, 16, 0
buffer_load_dwordx4 v[88:91], v74, s[16:19], s56 offen sc1
s_mov_b64 exec, -1
s_add_u32 s56, s56, 1024
s_waitcnt vmcnt(0)
s_bfm_b64 exec, 16, 0
v_cmp_eq_u32 vcc, s63, v91
s_mov_b64 exec, -1
v_subrev_u32 v88, s98, v88
v_cvt_f32_i32 v88, v88
s_cbranch_vccz L_noupd13
v_cndmask_b32 v88, 0, v88, vcc
v_cndmask_b32 v89, 0, v89, vcc
v_cndmask_b32 v90, 0, v90, vcc
v_cndmask_b32 v91, 0, 1.0, vcc
s_nop 0
v_add_f32_dpp v88, v88, v88 quad_perm:[1,0,3,2] row_mask:0xf bank_mask:0xf
v_add_f32_dpp v89, v89, v89 quad_perm:[1,0,3,2] row_mask:0xf bank_mask:0xf
v_add_f32_dpp v90, v90, v90 quad_perm:[1,0,3,2] row_mask:0xf bank_mask:0xf
v_add_f32_dpp v91, v91, v91 quad_perm:[1,0,3,2] row_mask:0xf bank_mask:0xf
v_add_f32_dpp v88, v88, v88 quad_perm:[2,3,0,1] row_mask:0xf bank_mask:0xf
v_add_f32_dpp v89, v89, v89 quad_perm:[2,3,0,1] row_mask:0xf bank_mask:0xf
v_add_f32_dpp v90, v90, v90 quad_perm:[2,3,0,1] row_mask:0xf bank_mask:0xf
v_add_f32_dpp v91, v91, v91 quad_perm:[2,3,0,1] row_mask:0xf bank_mask:0xf
v_add_f32_dpp v88, v88, v88 row_half_mirror row_mask:0xf bank_mask:0xf
v_add_f32_dpp v89, v89, v89 row_half_mirror row_mask:0xf bank_mask:0xf
v_add_f32_dpp v90, v90, v90 row_half_mirror row_mask:0xf bank_mask:0xf
v_add_f32_dpp v91, v91, v91 row_half_mirror row_mask:0xf bank_mask:0xf
v_add_f32_dpp v88, v88, v88 row_ror:8 row_mask:0xf bank_mask:0xf
v_add_f32_dpp v89, v89, v89 row_ror:8 row_mask:0xf bank_mask:0xf
v_add_f32_dpp v90, v90, v90 row_ror:8 row_mask:0xf bank_mask:0xf
v_add_f32_dpp v91, v91, v91 row_ror:8 row_mask:0xf bank_mask:0xf
v_mov_b32 v92, v88
v_mov_b32 v93, v89
v_mov_b32 v94, v90
v_mov_b32 v95, v91
s_nop 1
v_permlane16_swap_b32 v92, v88
v_permlane16_swap_b32 v93, v89
v_permlane16_swap_b32 v94, v90
v_permlane16_swap_b32 v95, v91
v_add_f32 v88, v92, v88
v_add_f32 v89, v93, v89
v_add_f32 v90, v94, v90
v_add_f32 v91, v95, v91
v_mov_b32 v92, v88
v_mov_b32 v93, v89
v_mov_b32 v94, v90
v_mov_b32 v95, v91
s_nop 1
v_permlane32_swap_b32 v92, v88
v_permlane32_swap_b32 v93, v89
v_permlane32_swap_b32 v94, v90
v_permlane32_swap_b32 v95, v91
v_add_f32 v88, v92, v88
v_add_f32 v89, v93, v89
v_add_f32 v90, v94, v90
v_add_f32 v91, v95, v91
v_rcp_f32 v91, v91
v_fmac_f32 v88, 0x3e800000, v89
v_mul_f32 v90, 0x3e800000, v90
v_mul_f32 v88, v88, v91
v_mul_f32 v90, v90, v91
v_sub_f32 v92, v88, v60
v_sub_f32 v93, v90, v61
v_rcp_f32 v93, v93
v_mov_b32 v62, v60
v_mov_b32 v63, v61
v_mov_b32 v60, v88
v_mov_b32 v61, v90
v_mul_f32 v92, v92, v93
v_max_f32 v92, 0x3f4ccccd, v92
v_min_f32 v92, 0x3fc00000, v92
v_fma_f32 v88, -v92, v90, v88
v_mul_f32 v89, 0x45800000, v92
v_add_f32 v88, 0x40a00000, v88
v_cvt_i32_f32 v88, v88
v_cvt_u32_f32 v89, v89
v_add_u32 v88, s98, v88
s_mov_b64 exec, 15
ds_write_b64 v70, v[88:89] offset:15904
s_mov_b64 exec, -1
L_noupd13:
s_mov_b32 s59, 3209
s_mov_b32 s38, 1048576
L_cw14:
s_sleep 8
ds_read_b32 v77, v71 offset:15876
s_waitcnt lgkmcnt(0)
v_cmp_le_u32 vcc, s59, v77
s_cbranch_vccnz L_cg14
s_sub_u32 s38, s38, 1
s_cbranch_scc0 L_cw14
L_cg14:
ds_read_b128 v[76:79], v71 offset:15872
ds_read_b128 v[80:83], v71 offset:15888
s_lshl_b32 s57, s98, 2
s_waitcnt lgkmcnt(0)
v_readfirstlane_b32 s58, v77
v_add3_u32 v85, v76, v78, v80
v_add_u32 v85, v85, v82
v_subrev_u32 v85, s57, v85
v_add3_u32 v86, v77, v79, v81
v_add_u32 v86, v86, v83
v_mov_b32 v84, s98
v_cvt_f32_u32 v85, v85
v_cvt_f32_u32 v86, v86
v_mov_b32 v87, s63
s_cmp_ge_u32 s2, 16
s_cbranch_scc1 L_nopub15
s_mov_b64 exec, 1
buffer_store_dwordx4 v[84:87], v71, s[16:19], s99 offen sc1
s_mov_b64 exec, -1
L_nopub15:
s_add_u32 s99, s99, 1024
s_mov_b32 s59, 3533
s_mov_b32 s38, 1048576
L_cw16:
s_sleep 8
ds_read_b32 v77, v71 offset:15876
s_waitcnt lgkmcnt(0)
v_cmp_le_u32 vcc, s59, v77
s_cbranch_vccnz L_cg16
s_sub_u32 s38, s38, 1
s_cbranch_scc0 L_cw16
L_cg16:
v_mov_b32 v91, 0
s_bfm_b64 exec, 16, 0
buffer_load_dwordx4 v[88:91], v74, s[16:19], s56 offen sc1
s_mov_b64 exec, -1
s_add_u32 s56, s56, 1024
s_waitcnt vmcnt(0)
s_bfm_b64 exec, 16, 0
v_cmp_eq_u32 vcc, s63, v91
s_mov_b64 exec, -1
v_subrev_u32 v88, s98, v88
v_cvt_f32_i32 v88, v88
s_cbranch_vccz L_noupd17
v_cndmask_b32 v88, 0, v88, vcc
v_cndmask_b32 v89, 0, v89, vcc
v_cndmask_b32 v90, 0, v90, vcc
v_cndmask_b32 v91, 0, 1.0, vcc
v_fma_f32 v64, v89, s92, v88
v_mul_f32 v65, s92, v90
v_cndmask_b32 v66, v67, 0, vcc
s_nop 0
v_add_f32_dpp v88, v88, v88 quad_perm:[1,0,3,2] row_mask:0xf bank_mask:0xf
v_add_f32_dpp v89, v89, v89 quad_perm:[1,0,3,2] row_mask:0xf bank_mask:0xf
v_add_f32_dpp v90, v90, v90 quad_perm:[1,0,3,2] row_mask:0xf bank_mask:0xf
v_add_f32_dpp v91, v91, v91 quad_perm:[1,0,3,2] row_mask:0xf bank_mask:0xf
v_add_f32_dpp v88, v88, v88 quad_perm:[2,3,0,1] row_mask:0xf bank_mask:0xf
v_add_f32_dpp v89, v89, v89 quad_perm:[2,3,0,1] row_mask:0xf bank_mask:0xf
v_add_f32_dpp v90, v90, v90 quad_perm:[2,3,0,1] row_mask:0xf bank_mask:0xf
v_add_f32_dpp v91, v91, v91 quad_perm:[2,3,0,1] row_mask:0xf bank_mask:0xf
v_add_f32_dpp v88, v88, v88 row_half_mirror row_mask:0xf bank_mask:0xf
v_add_f32_dpp v89, v89, v89 row_half_mirror row_mask:0xf bank_mask:0xf
v_add_f32_dpp v90, v90, v90 row_half_mirror row_mask:0xf bank_mask:0xf
v_add_f32_dpp v91, v91, v91 row_half_mirror row_mask:0xf bank_mask:0xf
v_add_f32_dpp v88, v88, v88 row_ror:8 row_mask:0xf bank_mask:0xf
v_add_f32_dpp v89, v89, v89 row_ror:8 row_mask:0xf bank_mask:0xf
v_add_f32_dpp v90, v90, v90 row_ror:8 row_mask:0xf bank_mask:0xf
v_add_f32_dpp v91, v91, v91 row_ror:8 row_mask:0xf bank_mask:0xf
v_mov_b32 v92, v88
v_mov_b32 v93, v89
v_mov_b32 v94, v90
v_mov_b32 v95, v91
s_nop 1
v_permlane16_swap_b32 v92, v88
v_permlane16_swap_b32 v93, v89
v_permlane16_swap_b32 v94, v90
v_permlane16_swap_b32 v95, v91
v_add_f32 v88, v92, v88
v_add_f32 v89, v93, v89
v_add_f32 v90, v94, v90
v_add_f32 v91, v95, v91
v_mov_b32 v92, v88
v_mov_b32 v93, v89
v_mov_b32 v94, v90
v_mov_b32 v95, v91
s_nop 1
v_permlane32_swap_b32 v92, v88
v_permlane32_swap_b32 v93, v89
v_permlane32_swap_b32 v94, v90
v_permlane32_swap_b32 v95, v91
v_add_f32 v88, v92, v88
v_add_f32 v89, v93, v89
v_add_f32 v90, v94, v90
v_add_f32 v91, v95, v91
v_rcp_f32 v91, v91
v_fmac_f32 v88, 0x3e800000, v89
v_mul_f32 v90, 0x3e800000, v90
v_mul_f32 v88, v88, v91
v_mul_f32 v90, v90, v91
v_sub_f32 v92, v88, v60
v_sub_f32 v93, v90, v61
v_rcp_f32 v93, v93
v_mov_b32 v62, v60
v_mov_b32 v63, v61
v_mov_b32 v60, v88
v_mov_b32 v61, v90
v_mul_f32 v92, v92, v93
v_max_f32 v92, 0x3f4ccccd, v92
v_min_f32 v92, 0x3fc00000, v92
v_fma_f32 v88, -v92, v90, v88
v_fma_f32 v64, -v92, v65, v64
v_sub_f32 v64, v64, v88
v_cndmask_b32 v64, v66, v64, vcc
s_nop 1
s_nop 1
v_max_f32_dpp v64, v64, v64 quad_perm:[1,0,3,2] row_mask:0xf bank_mask:0xf
s_nop 1
v_max_f32_dpp v64, v64, v64 quad_perm:[2,3,0,1] row_mask:0xf bank_mask:0xf
s_nop 1
v_max_f32_dpp v64, v64, v64 row_half_mirror row_mask:0xf bank_mask:0xf
s_nop 1
v_max_f32_dpp v64, v64, v64 row_ror:8 row_mask:0xf bank_mask:0xf
v_mov_b32 v65, v64
s_nop 1
v_permlane16_swap_b32 v65, v64
v_max_f32 v64, v65, v64
v_mov_b32 v65, v64
s_nop 1
v_permlane32_swap_b32 v65, v64
v_max_f32 v64, v65, v64
v_subrev_f32 v64, 0x41f00000, v64
v_max_f32 v64, 0, v64
v_mul_f32 v64, 0x3f000000, v64
v_min_f32 v64, 0x43160000, v64
v_add_f32 v88, v88, v64
v_mul_f32 v89, 0x45800000, v92
v_add_f32 v88, 0x40a00000, v88
v_cvt_i32_f32 v88, v88
v_cvt_u32_f32 v89, v89
v_add_u32 v88, s98, v88
s_mov_b64 exec, 15
ds_write_b64 v70, v[88:89] offset:15904
s_mov_b64 exec, -1
L_noupd17:
s_mov_b32 s59, 3857
s_mov_b32 s38, 1048576
L_cw18:
s_sleep 8
ds_read_b32 v77, v71 offset:15876
s_waitcnt lgkmcnt(0)
v_cmp_le_u32 vcc, s59, v77
s_cbranch_vccnz L_cg18
s_sub_u32 s38, s38, 1
s_cbranch_scc0 L_cw18
L_cg18:
ds_read_b128 v[76:79], v71 offset:15872
ds_read_b128 v[80:83], v71 offset:15888
s_lshl_b32 s57, s98, 2
s_waitcnt lgkmcnt(0)
v_readfirstlane_b32 s58, v77
v_add3_u32 v85, v76, v78, v80
v_add_u32 v85, v85, v82
v_subrev_u32 v85, s57, v85
v_add3_u32 v86, v77, v79, v81
v_add_u32 v86, v86, v83
v_mov_b32 v84, s98
v_cvt_f32_u32 v85, v85
v_cvt_f32_u32 v86, v86
v_mov_b32 v87, s63
s_cmp_ge_u32 s2, 16
s_cbranch_scc1 L_nopub19
s_mov_b64 exec, 1
buffer_store_dwordx4 v[84:87], v71, s[16:19], s99 offen sc1
s_mov_b64 exec, -1
L_nopub19:
s_add_u32 s99, s99, 1024
s_mov_b32 s59, 4181
s_mov_b32 s38, 1048576
L_cw20:
s_sleep 8
ds_read_b32 v77, v71 offset:15876
s_waitcnt lgkmcnt(0)
v_cmp_le_u32 vcc, s59, v77
s_cbranch_vccnz L_cg20
s_sub_u32 s38, s38, 1
s_cbranch_scc0 L_cw20
L_cg20:
v_mov_b32 v91, 0
s_bfm_b64 exec, 16, 0
buffer_load_dwordx4 v[88:91], v74, s[16:19], s56 offen sc1
s_mov_b64 exec, -1
s_add_u32 s56, s56, 1024
s_waitcnt vmcnt(0)
s_bfm_b64 exec, 16, 0
v_cmp_eq_u32 vcc, s63, v91
s_mov_b64 exec, -1
v_subrev_u32 v88, s98, v88
v_cvt_f32_i32 v88, v88
s_cbranch_vccz L_noupd21
v_cndmask_b32 v88, 0, v88, vcc
v_cndmask_b32 v89, 0, v89, vcc
v_cndmask_b32 v90, 0, v90, vcc
v_cndmask_b32 v91, 0, 1.0, vcc
v_fma_f32 v64, v89, s92, v88
v_mul_f32 v65, s92, v90
v_cndmask_b32 v66, v67, 0, vcc
s_nop 0
v_add_f32_dpp v88, v88, v88 quad_perm:[1,0,3,2] row_mask:0xf bank_mask:0xf
v_add_f32_dpp v89, v89, v89 quad_perm:[1,0,3,2] row_mask:0xf bank_mask:0xf
v_add_f32_dpp v90, v90, v90 quad_perm:[1,0,3,2] row_mask:0xf bank_mask:0xf
v_add_f32_dpp v91, v91, v91 quad_perm:[1,0,3,2] row_mask:0xf bank_mask:0xf
v_add_f32_dpp v88, v88, v88 quad_perm:[2,3,0,1] row_mask:0xf bank_mask:0xf
v_add_f32_dpp v89, v89, v89 quad_perm:[2,3,0,1] row_mask:0xf bank_mask:0xf
v_add_f32_dpp v90, v90, v90 quad_perm:[2,3,0,1] row_mask:0xf bank_mask:0xf
v_add_f32_dpp v91, v91, v91 quad_perm:[2,3,0,1] row_mask:0xf bank_mask:0xf
v_add_f32_dpp v88, v88, v88 row_half_mirror row_mask:0xf bank_mask:0xf
v_add_f32_dpp v89, v89, v89 row_half_mirror row_mask:0xf bank_mask:0xf
v_add_f32_dpp v90, v90, v90 row_half_mirror row_mask:0xf bank_mask:0xf
v_add_f32_dpp v91, v91, v91 row_half_mirror row_mask:0xf bank_mask:0xf
v_add_f32_dpp v88, v88, v88 row_ror:8 row_mask:0xf bank_mask:0xf
v_add_f32_dpp v89, v89, v89 row_ror:8 row_mask:0xf bank_mask:0xf
v_add_f32_dpp v90, v90, v90 row_ror:8 row_mask:0xf bank_mask:0xf
v_add_f32_dpp v91, v91, v91 row_ror:8 row_mask:0xf bank_mask:0xf
v_mov_b32 v92, v88
v_mov_b32 v93, v89
v_mov_b32 v94, v90
v_mov_b32 v95, v91
s_nop 1
v_permlane16_swap_b32 v92, v88
v_permlane16_swap_b32 v93, v89
v_permlane16_swap_b32 v94, v90
v_permlane16_swap_b32 v95, v91
v_add_f32 v88, v92, v88
v_add_f32 v89, v93, v89
v_add_f32 v90, v94, v90
v_add_f32 v91, v95, v91
v_mov_b32 v92, v88
v_mov_b32 v93, v89
v_mov_b32 v94, v90
v_mov_b32 v95, v91
s_nop 1
v_permlane32_swap_b32 v92, v88
v_permlane32_swap_b32 v93, v89
v_permlane32_swap_b32 v94, v90
v_permlane32_swap_b32 v95, v91
v_add_f32 v88, v92, v88
v_add_f32 v89, v93, v89
v_add_f32 v90, v94, v90
v_add_f32 v91, v95, v91
v_rcp_f32 v91, v91
v_fmac_f32 v88, 0x3e800000, v89
v_mul_f32 v90, 0x3e800000, v90
v_mul_f32 v88, v88, v91
v_mul_f32 v90, v90, v91
v_sub_f32 v92, v88, v60
v_sub_f32 v93, v90, v61
v_rcp_f32 v93, v93
v_mov_b32 v62, v60
v_mov_b32 v63, v61
v_mov_b32 v60, v88
v_mov_b32 v61, v90
v_mul_f32 v92, v92, v93
v_max_f32 v92, 0x3f4ccccd, v92
v_min_f32 v92, 0x3fc00000, v92
v_fma_f32 v88, -v92, v90, v88
v_fma_f32 v64, -v92, v65, v64
v_sub_f32 v64, v64, v88
v_cndmask_b32 v64, v66, v64, vcc
s_nop 1
s_nop 1
v_max_f32_dpp v64, v64, v64 quad_perm:[1,0,3,2] row_mask:0xf bank_mask:0xf
s_nop 1
v_max_f32_dpp v64, v64, v64 quad_perm:[2,3,0,1] row_mask:0xf bank_mask:0xf
s_nop 1
v_max_f32_dpp v64, v64, v64 row_half_mirror row_mask:0xf bank_mask:0xf
s_nop 1
v_max_f32_dpp v64, v64, v64 row_ror:8 row_mask:0xf bank_mask:0xf
v_mov_b32 v65, v64
s_nop 1
v_permlane16_swap_b32 v65, v64
v_max_f32 v64, v65, v64
v_mov_b32 v65, v64
s_nop 1
v_permlane32_swap_b32 v65, v64
v_max_f32 v64, v65, v64
v_subrev_f32 v64, 0x41f00000, v64
v_max_f32 v64, 0, v64
v_mul_f32 v64, 0x3f000000, v64
v_min_f32 v64, 0x43160000, v64
v_add_f32 v88, v88, v64
v_mul_f32 v89, 0x45800000, v92
v_add_f32 v88, 0x40a00000, v88
v_cvt_i32_f32 v88, v88
v_cvt_u32_f32 v89, v89
v_add_u32 v88, s98, v88
s_mov_b64 exec, 15
ds_write_b64 v70, v[88:89] offset:15904
s_mov_b64 exec, -1
L_noupd21:
s_mov_b32 s59, 4506
s_mov_b32 s38, 1048576
L_cw22:
s_sleep 8
ds_read_b32 v77, v71 offset:15876
s_waitcnt lgkmcnt(0)
v_cmp_le_u32 vcc, s59, v77
s_cbranch_vccnz L_cg22
s_sub_u32 s38, s38, 1
s_cbranch_scc0 L_cw22
L_cg22:
ds_read_b128 v[76:79], v71 offset:15872
ds_read_b128 v[80:83], v71 offset:15888
s_lshl_b32 s57, s98, 2
s_waitcnt lgkmcnt(0)
v_readfirstlane_b32 s58, v77
v_add3_u32 v85, v76, v78, v80
v_add_u32 v85, v85, v82
v_subrev_u32 v85, s57, v85
v_add3_u32 v86, v77, v79, v81
v_add_u32 v86, v86, v83
v_mov_b32 v84, s98
v_cvt_f32_u32 v85, v85
v_cvt_f32_u32 v86, v86
v_mov_b32 v87, s63
s_cmp_ge_u32 s2, 16
s_cbranch_scc1 L_nopub23
s_mov_b64 exec, 1
buffer_store_dwordx4 v[84:87], v71, s[16:19], s99 offen sc1
s_mov_b64 exec, -1
L_nopub23:
s_add_u32 s99, s99, 1024
s_mov_b32 s59, 4830
s_mov_b32 s38, 1048576
L_cw24:
s_sleep 8
ds_read_b32 v77, v71 offset:15876
s_waitcnt lgkmcnt(0)
v_cmp_le_u32 vcc, s59, v77
s_cbranch_vccnz L_cg24
s_sub_u32 s38, s38, 1
s_cbranch_scc0 L_cw24
L_cg24:
v_mov_b32 v91, 0
s_bfm_b64 exec, 16, 0
buffer_load_dwordx4 v[88:91], v74, s[16:19], s56 offen sc1
s_mov_b64 exec, -1
s_add_u32 s56, s56, 1024
s_waitcnt vmcnt(0)
s_bfm_b64 exec, 16, 0
v_cmp_eq_u32 vcc, s63, v91
s_mov_b64 exec, -1
v_subrev_u32 v88, s98, v88
v_cvt_f32_i32 v88, v88
s_cbranch_vccz L_noupd25
v_cndmask_b32 v88, 0, v88, vcc
v_cndmask_b32 v89, 0, v89, vcc
v_cndmask_b32 v90, 0, v90, vcc
v_cndmask_b32 v91, 0, 1.0, vcc
v_fma_f32 v64, v89, s92, v88
v_mul_f32 v65, s92, v90
v_cndmask_b32 v66, v67, 0, vcc
s_nop 0
v_add_f32_dpp v88, v88, v88 quad_perm:[1,0,3,2] row_mask:0xf bank_mask:0xf
v_add_f32_dpp v89, v89, v89 quad_perm:[1,0,3,2] row_mask:0xf bank_mask:0xf
v_add_f32_dpp v90, v90, v90 quad_perm:[1,0,3,2] row_mask:0xf bank_mask:0xf
v_add_f32_dpp v91, v91, v91 quad_perm:[1,0,3,2] row_mask:0xf bank_mask:0xf
v_add_f32_dpp v88, v88, v88 quad_perm:[2,3,0,1] row_mask:0xf bank_mask:0xf
v_add_f32_dpp v89, v89, v89 quad_perm:[2,3,0,1] row_mask:0xf bank_mask:0xf
v_add_f32_dpp v90, v90, v90 quad_perm:[2,3,0,1] row_mask:0xf bank_mask:0xf
v_add_f32_dpp v91, v91, v91 quad_perm:[2,3,0,1] row_mask:0xf bank_mask:0xf
v_add_f32_dpp v88, v88, v88 row_half_mirror row_mask:0xf bank_mask:0xf
v_add_f32_dpp v89, v89, v89 row_half_mirror row_mask:0xf bank_mask:0xf
v_add_f32_dpp v90, v90, v90 row_half_mirror row_mask:0xf bank_mask:0xf
v_add_f32_dpp v91, v91, v91 row_half_mirror row_mask:0xf bank_mask:0xf
v_add_f32_dpp v88, v88, v88 row_ror:8 row_mask:0xf bank_mask:0xf
v_add_f32_dpp v89, v89, v89 row_ror:8 row_mask:0xf bank_mask:0xf
v_add_f32_dpp v90, v90, v90 row_ror:8 row_mask:0xf bank_mask:0xf
v_add_f32_dpp v91, v91, v91 row_ror:8 row_mask:0xf bank_mask:0xf
v_mov_b32 v92, v88
v_mov_b32 v93, v89
v_mov_b32 v94, v90
v_mov_b32 v95, v91
s_nop 1
v_permlane16_swap_b32 v92, v88
v_permlane16_swap_b32 v93, v89
v_permlane16_swap_b32 v94, v90
v_permlane16_swap_b32 v95, v91
v_add_f32 v88, v92, v88
v_add_f32 v89, v93, v89
v_add_f32 v90, v94, v90
v_add_f32 v91, v95, v91
v_mov_b32 v92, v88
v_mov_b32 v93, v89
v_mov_b32 v94, v90
v_mov_b32 v95, v91
s_nop 1
v_permlane32_swap_b32 v92, v88
v_permlane32_swap_b32 v93, v89
v_permlane32_swap_b32 v94, v90
v_permlane32_swap_b32 v95, v91
v_add_f32 v88, v92, v88
v_add_f32 v89, v93, v89
v_add_f32 v90, v94, v90
v_add_f32 v91, v95, v91
v_rcp_f32 v91, v91
v_fmac_f32 v88, 0x3e800000, v89
v_mul_f32 v90, 0x3e800000, v90
v_mul_f32 v88, v88, v91
v_mul_f32 v90, v90, v91
v_sub_f32 v92, v88, v60
v_sub_f32 v93, v90, v61
v_rcp_f32 v93, v93
v_mov_b32 v62, v60
v_mov_b32 v63, v61
v_mov_b32 v60, v88
v_mov_b32 v61, v90
v_mul_f32 v92, v92, v93
v_max_f32 v92, 0x3f4ccccd, v92
v_min_f32 v92, 0x3fc00000, v92
v_fma_f32 v88, -v92, v90, v88
v_fma_f32 v64, -v92, v65, v64
v_sub_f32 v64, v64, v88
v_cndmask_b32 v64, v66, v64, vcc
s_nop 1
s_nop 1
v_max_f32_dpp v64, v64, v64 quad_perm:[1,0,3,2] row_mask:0xf bank_mask:0xf
s_nop 1
v_max_f32_dpp v64, v64, v64 quad_perm:[2,3,0,1] row_mask:0xf bank_mask:0xf
s_nop 1
v_max_f32_dpp v64, v64, v64 row_half_mirror row_mask:0xf bank_mask:0xf
s_nop 1
v_max_f32_dpp v64, v64, v64 row_ror:8 row_mask:0xf bank_mask:0xf
v_mov_b32 v65, v64
s_nop 1
v_permlane16_swap_b32 v65, v64
v_max_f32 v64, v65, v64
v_mov_b32 v65, v64
s_nop 1
v_permlane32_swap_b32 v65, v64
v_max_f32 v64, v65, v64
v_subrev_f32 v64, 0x41f00000, v64
v_max_f32 v64, 0, v64
v_mul_f32 v64, 0x3f000000, v64
v_min_f32 v64, 0x43160000, v64
v_add_f32 v88, v88, v64
v_mul_f32 v89, 0x45800000, v92
v_add_f32 v88, 0x40a00000, v88
v_cvt_i32_f32 v88, v88
v_cvt_u32_f32 v89, v89
v_add_u32 v88, s98, v88
s_mov_b64 exec, 15
ds_write_b64 v70, v[88:89] offset:15904
s_mov_b64 exec, -1
L_noupd25:
s_mov_b32 s59, 4992
s_mov_b32 s38, 1048576
L_cw26:
s_sleep 8
ds_read_b32 v77, v71 offset:15876
s_waitcnt lgkmcnt(0)
v_cmp_le_u32 vcc, s59, v77
s_cbranch_vccnz L_cg26
s_sub_u32 s38, s38, 1
s_cbranch_scc0 L_cw26
L_cg26:
ds_read_b128 v[76:79], v71 offset:15872
ds_read_b128 v[80:83], v71 offset:15888
s_lshl_b32 s57, s98, 2
s_waitcnt lgkmcnt(0)
v_readfirstlane_b32 s58, v77
v_add3_u32 v85, v76, v78, v80
v_add_u32 v85, v85, v82
v_subrev_u32 v85, s57, v85
v_add3_u32 v86, v77, v79, v81
v_add_u32 v86, v86, v83
v_mov_b32 v84, s98
v_cvt_f32_u32 v85, v85
v_cvt_f32_u32 v86, v86
v_mov_b32 v87, s63
s_cmp_ge_u32 s2, 16
s_cbranch_scc1 L_nopub27
s_mov_b64 exec, 1
buffer_store_dwordx4 v[84:87], v71, s[16:19], s99 offen sc1
s_mov_b64 exec, -1
L_nopub27:
s_add_u32 s99, s99, 1024
s_mov_b32 s59, 5316
s_mov_b32 s38, 1048576
L_cw28:
s_sleep 8
ds_read_b32 v77, v71 offset:15876
s_waitcnt lgkmcnt(0)
v_cmp_le_u32 vcc, s59, v77
s_cbranch_vccnz L_cg28
s_sub_u32 s38, s38, 1
s_cbranch_scc0 L_cw28
L_cg28:
v_mov_b32 v91, 0
s_bfm_b64 exec, 16, 0
buffer_load_dwordx4 v[88:91], v74, s[16:19], s56 offen sc1
s_mov_b64 exec, -1
s_add_u32 s56, s56, 1024
s_waitcnt vmcnt(0)
s_bfm_b64 exec, 16, 0
v_cmp_eq_u32 vcc, s63, v91
s_mov_b64 exec, -1
v_subrev_u32 v88, s98, v88
v_cvt_f32_i32 v88, v88
s_cbranch_vccz L_noupd29
v_cndmask_b32 v88, 0, v88, vcc
v_cndmask_b32 v89, 0, v89, vcc
v_cndmask_b32 v90, 0, v90, vcc
v_cndmask_b32 v91, 0, 1.0, vcc
v_fma_f32 v64, v89, s92, v88
v_mul_f32 v65, s92, v90
v_cndmask_b32 v66, v67, 0, vcc
s_nop 0
v_add_f32_dpp v88, v88, v88 quad_perm:[1,0,3,2] row_mask:0xf bank_mask:0xf
v_add_f32_dpp v89, v89, v89 quad_perm:[1,0,3,2] row_mask:0xf bank_mask:0xf
v_add_f32_dpp v90, v90, v90 quad_perm:[1,0,3,2] row_mask:0xf bank_mask:0xf
v_add_f32_dpp v91, v91, v91 quad_perm:[1,0,3,2] row_mask:0xf bank_mask:0xf
v_add_f32_dpp v88, v88, v88 quad_perm:[2,3,0,1] row_mask:0xf bank_mask:0xf
v_add_f32_dpp v89, v89, v89 quad_perm:[2,3,0,1] row_mask:0xf bank_mask:0xf
v_add_f32_dpp v90, v90, v90 quad_perm:[2,3,0,1] row_mask:0xf bank_mask:0xf
v_add_f32_dpp v91, v91, v91 quad_perm:[2,3,0,1] row_mask:0xf bank_mask:0xf
v_add_f32_dpp v88, v88, v88 row_half_mirror row_mask:0xf bank_mask:0xf
v_add_f32_dpp v89, v89, v89 row_half_mirror row_mask:0xf bank_mask:0xf
v_add_f32_dpp v90, v90, v90 row_half_mirror row_mask:0xf bank_mask:0xf
v_add_f32_dpp v91, v91, v91 row_half_mirror row_mask:0xf bank_mask:0xf
v_add_f32_dpp v88, v88, v88 row_ror:8 row_mask:0xf bank_mask:0xf
v_add_f32_dpp v89, v89, v89 row_ror:8 row_mask:0xf bank_mask:0xf
v_add_f32_dpp v90, v90, v90 row_ror:8 row_mask:0xf bank_mask:0xf
v_add_f32_dpp v91, v91, v91 row_ror:8 row_mask:0xf bank_mask:0xf
v_mov_b32 v92, v88
v_mov_b32 v93, v89
v_mov_b32 v94, v90
v_mov_b32 v95, v91
s_nop 1
v_permlane16_swap_b32 v92, v88
v_permlane16_swap_b32 v93, v89
v_permlane16_swap_b32 v94, v90
v_permlane16_swap_b32 v95, v91
v_add_f32 v88, v92, v88
v_add_f32 v89, v93, v89
v_add_f32 v90, v94, v90
v_add_f32 v91, v95, v91
v_mov_b32 v92, v88
v_mov_b32 v93, v89
v_mov_b32 v94, v90
v_mov_b32 v95, v91
s_nop 1
v_permlane32_swap_b32 v92, v88
v_permlane32_swap_b32 v93, v89
v_permlane32_swap_b32 v94, v90
v_permlane32_swap_b32 v95, v91
v_add_f32 v88, v92, v88
v_add_f32 v89, v93, v89
v_add_f32 v90, v94, v90
v_add_f32 v91, v95, v91
v_rcp_f32 v91, v91
v_fmac_f32 v88, 0x3e800000, v89
v_mul_f32 v90, 0x3e800000, v90
v_mul_f32 v88, v88, v91
v_mul_f32 v90, v90, v91
v_sub_f32 v92, v88, v60
v_sub_f32 v93, v90, v61
v_rcp_f32 v93, v93
v_mov_b32 v62, v60
v_mov_b32 v63, v61
v_mov_b32 v60, v88
v_mov_b32 v61, v90
v_mul_f32 v92, v92, v93
v_max_f32 v92, 0x3f4ccccd, v92
v_min_f32 v92, 0x3fc00000, v92
v_fma_f32 v88, -v92, v90, v88
v_fma_f32 v64, -v92, v65, v64
v_sub_f32 v64, v64, v88
v_cndmask_b32 v64, v66, v64, vcc
s_nop 1
s_nop 1
v_max_f32_dpp v64, v64, v64 quad_perm:[1,0,3,2] row_mask:0xf bank_mask:0xf
s_nop 1
v_max_f32_dpp v64, v64, v64 quad_perm:[2,3,0,1] row_mask:0xf bank_mask:0xf
s_nop 1
v_max_f32_dpp v64, v64, v64 row_half_mirror row_mask:0xf bank_mask:0xf
s_nop 1
v_max_f32_dpp v64, v64, v64 row_ror:8 row_mask:0xf bank_mask:0xf
v_mov_b32 v65, v64
s_nop 1
v_permlane16_swap_b32 v65, v64
v_max_f32 v64, v65, v64
v_mov_b32 v65, v64
s_nop 1
v_permlane32_swap_b32 v65, v64
v_max_f32 v64, v65, v64
v_subrev_f32 v64, 0x41f00000, v64
v_max_f32 v64, 0, v64
v_mul_f32 v64, 0x3f000000, v64
v_min_f32 v64, 0x43160000, v64
v_add_f32 v88, v88, v64
v_mul_f32 v89, 0x45800000, v92
v_add_f32 v88, 0x40a00000, v88
v_cvt_i32_f32 v88, v88
v_cvt_u32_f32 v89, v89
v_add_u32 v88, s98, v88
s_mov_b64 exec, 15
ds_write_b64 v70, v[88:89] offset:15904
s_mov_b64 exec, -1
L_noupd29:
s_barrier
L_fin:
L_end:
s_endpgm
.section .rodata,"a"
.p2align 6
.amdhsa_kernel parallel_sum__gqa_block_cached__glu_gated_reglu__decode_kernel
  .amdhsa_next_free_vgpr 256
  .amdhsa_next_free_sgpr 102
  .amdhsa_accum_offset 256
  .amdhsa_group_segment_fixed_size 0
  .amdhsa_kernarg_size 96
  .amdhsa_user_sgpr_count 2
  .amdhsa_user_sgpr_kernarg_segment_ptr 1
  .amdhsa_system_sgpr_workgroup_id_x 1
.end_amdhsa_kernel
```
